```python
import torch

def _softmax(x, axis=-1):
    return torch.softmax(x, dim=axis)
def _gelu(x):
    return torch.nn.functional.gelu(x, approximate="tanh")
def _silu(x):
    return torch.nn.functional.silu(x)
def _sigmoid(x):
    return torch.sigmoid(x)
def _layernorm(x, axis=-1, eps=1e-5):
    m = x.mean(dim=axis, keepdim=True)
    v = x.var(dim=axis, keepdim=True, unbiased=False)
    return (x - m) / torch.sqrt(v + eps)
def _scatter_add(tgt, idx, src, axis=0):
    return tgt.clone().index_add_(axis, idx, src)
def _segment_sum(src, seg, n):
    out = torch.zeros((n,) + src.shape[1:], dtype=src.dtype)
    return out.index_add_(0, seg, src)
def _pad(x, pw):
    flat = tuple(v for pair in reversed(pw) for v in pair)
    return torch.nn.functional.pad(x, flat)

kernel_name = 'sequential_preLN__linear_attn_block__glu_gated_swiglu__prompt'

def setup_inputs():

    _w = (lambda a: (lambda t: t.to(torch.bfloat16) if t.is_floating_point() else t)(torch.as_tensor(a)))
    def _A_setup():
        B, S, D = 1, 2048, 512
        return {
            "x": _w((lambda *s: torch.randn(*s, dtype=torch.bfloat16) * 0.05)(B, S, D)),
            "wqkv": _w((lambda *s: torch.randn(*s, dtype=torch.bfloat16) * 0.05)(D, 3 * D)),
            "wo": _w((lambda *s: torch.randn(*s, dtype=torch.bfloat16) * 0.05)(D, D)),
        }
    _A_in = _A_setup()

    def _B_setup():
        B, S, D, F = 1, 2048, 512, 1792
        return {
            "x": _w((lambda *s: torch.randn(*s, dtype=torch.bfloat16) * 0.05)(B, S, D)),
            "w1": _w((lambda *s: torch.randn(*s, dtype=torch.bfloat16) * 0.2)(D, F) * (2.0 / D) ** 0.5),
            "w3": _w((lambda *s: torch.randn(*s, dtype=torch.bfloat16) * 0.2)(D, F) * (2.0 / D) ** 0.5),
            "w2": _w((lambda *s: torch.randn(*s, dtype=torch.bfloat16) * 0.2)(F, D) * (2.0 / F) ** 0.5),
        }
    _B_in = _B_setup()

    return {
        "A_x": _A_in["x"],
        "A_wqkv": _A_in["wqkv"],
        "A_wo": _A_in["wo"],
        "B_x": _B_in["x"],
        "B_w1": _B_in["w1"],
        "B_w3": _B_in["w3"],
        "B_w2": _B_in["w2"],
    }

def reference(A_x, A_wqkv, A_wo, B_x, B_w1, B_w3, B_w2):
    def _A_ref(x, wqkv, wo):
        B, S, D = x.shape
        H = 32; Dh = D // H
        qkv = (lambda x, *d: x.permute(*d))((x @ wqkv).reshape(B, S, 3, H, Dh), 2, 0, 3, 1, 4)
        q, k, v = qkv[0], qkv[1], qkv[2]
        phi = lambda t: torch.where(t > 0, t + 1, torch.exp(t)) + 1e-6
        pq, pk = phi(q), phi(k)
        kv = torch.einsum("bhsd,bhse->bhde", pk, v)
        z = torch.einsum("bhsd->bhd", pk)
        num = torch.einsum("bhqd,bhde->bhqe", pq, kv)
        den = torch.einsum("bhqd,bhd->bhq", pq, z)[..., None] + 1e-6
        o = num / den
        return (lambda x, *d: x.permute(*d))(o, 0, 2, 1, 3).reshape(B, S, D) @ wo

    def _B_ref(x, w1, w3, w2):
        gate = torch.einsum("bsd,df->bsf", x, w1)
        up = torch.einsum("bsd,df->bsf", x, w3)
        h = _silu(gate) * up
        out = torch.einsum("bsf,fd->bsd", h, w2)
        return out

    x = A_x
    h = x + _A_ref(_layernorm(x, axis=-1), A_wqkv, A_wo)
    h2 = h + _B_ref(_layernorm(h, axis=-1), B_w1, B_w3, B_w2)
    return h2
```

```asm
; @launch grid=(256,1,1) block=(256,1,1) lds=163840
.amdgcn_target "amdgcn-amd-amdhsa--gfx950"
.text
.globl sequential_preLN__linear_attn_block__glu_gated_swiglu__prompt_kernel
.p2align 12
.p2align 8
.type sequential_preLN__linear_attn_block__glu_gated_swiglu__prompt_kernel,@function
sequential_preLN__linear_attn_block__glu_gated_swiglu__prompt_kernel:
    s_load_dwordx2 s[8:9], s[0:1], 0
    s_load_dwordx2 s[12:13], s[0:1], 8
    s_load_dwordx2 s[36:37], s[0:1], 72
    s_cmp_ge_u32 s2, 256
    s_cbranch_scc1 L_end
    s_getpc_b64 s[48:49]
L_pc:
    s_lshr_b32 s45, s2, 3
    s_lshl_b32 s47, s45, 10
    v_lshl_add_u32 v14, v0, 2, s47
    v_lshrrev_b32 v1, 6, v0
    v_min_u32 v14, L_last-L_pc, v14
    v_readfirstlane_b32 s3, v1
    global_load_dword v15, v14, s[48:49]
    v_and_b32 v0, 63, v0
    s_and_b32 s6, s2, 1
    s_and_b32 s5, s45, 3
    s_lshr_b32 s47, s45, 2
    s_bfe_u32 s48, s2, 0x20001
    s_lshl3_add_u32 s4, s48, s47
    s_xor_b32 s44, s5, s47
    s_lshl2_add_u32 s44, s44, s2
    s_and_b32 s44, s44, 7
    v_lshrrev_b32 v18, 3, v0
    v_lshrrev_b32 v19, 4, v0
    v_and_b32 v1, 7, v0
    s_lshl2_add_u32 s47, s4, s3
    s_lshl_b32 s47, s47, 14
    v_xor_b32 v3, v1, v19
    v_lshl_add_u32 v2, v18, 10, s47
    v_lshl_add_u32 v2, v3, 4, v2
    s_lshl_b32 s51, s44, 7
    s_lshl_b32 s66, s3, 11
    s_mov_b32 s10, 2097152
    s_mov_b32 s11, 0x20000
    v_xor_b32 v3, 64, v2
    v_add_u32 v3, 7168, v3
    s_add_u32 m0, s66, 0
    s_waitcnt lgkmcnt(0)
    buffer_load_dwordx4 v2, s[8:11], s51 offen  lds
    buffer_load_dwordx4 v3, s[8:11], s51 offen offset:1024  lds
    s_lshl2_add_u32 s7, s6, s5
    s_mul_i32 s48, s3, 49152
    s_lshl_b32 s49, s7, 7
    s_add_u32 s48, s48, s49
    v_mul_u32_u24 v4, 3072, v18
    v_and_b32 v5, 2, v18
    v_xor_b32 v5, v5, v1
    v_lshl_add_u32 v6, v5, 4, v4
    v_add_u32 v6, s48, v6
    s_mov_b32 s14, 1572864
    s_mov_b32 s15, 0x20000
    s_mul_i32 s52, s44, 196608
    s_lshl_b32 s67, s3, 12
    v_add_u32 v4, 1024, v6
    v_xor_b32 v7, 64, v6
    v_add_u32 v7, 22528, v7
    v_add_u32 v5, 1024, v7
    s_add_u32 m0, s67, 65536
    s_nop 0
    buffer_load_dwordx4 v4, s[12:15], s52 offen  lds
    s_add_u32 s51, s51, 128
    buffer_load_dwordx4 v4, s[12:15], s52 offen offset:1024  lds
    s_and_b32 s51, s51, 1023
    buffer_load_dwordx4 v5, s[12:15], s52 offen offset:2048  lds
    buffer_load_dwordx4 v5, s[12:15], s52 offen offset:3072  lds
    s_mul_i32 s52, s51, 1536
    s_load_dwordx2 s[16:17], s[0:1], 16
    s_load_dwordx2 s[40:41], s[0:1], 64
    s_load_dwordx2 s[20:21], s[0:1], 32
    s_load_dwordx2 s[24:25], s[0:1], 40
    s_load_dwordx2 s[28:29], s[0:1], 48
    s_load_dwordx2 s[32:33], s[0:1], 56
    s_lshl2_add_u32 s47, s45, s3
    s_mul_i32 s47, s47, 12288
    s_lshl_b32 s48, s6, 30
    s_add_u32 s47, s47, s48
    v_lshl_add_u32 v160, v0, 10, s47
    s_mov_b64 exec, 0xfff
    buffer_load_dword v161, v160, s[12:15], 0 offen offset:384
    s_mov_b64 exec, -1
    s_add_u32 m0, s66, 8192
    s_nop 0
    buffer_load_dwordx4 v2, s[8:11], s51 offen  lds
    buffer_load_dwordx4 v3, s[8:11], s51 offen offset:1024  lds
    s_mov_b32 s18, 524288
    s_mov_b32 s19, 0x20000
    s_mov_b32 s22, 1835008
    s_mov_b32 s23, 0x20000
    s_mov_b32 s26, 1835008
    s_mov_b32 s27, 0x20000
    s_mov_b32 s30, 1835008
    s_mov_b32 s31, 0x20000
    s_mov_b32 s34, 2097152
    s_mov_b32 s35, 0x20000
    s_mov_b32 s38, 18874368
    s_mov_b32 s39, 0x20000
    s_mov_b32 s42, 256
    s_mov_b32 s43, 0x20000
    s_and_b32 s46, s2, 7
    v_lshlrev_b32 v16, 4, v0
    v_lshlrev_b32 v17, 2, v0
    s_lshl2_add_u32 s65, s2, s3
    s_lshl1_add_u32 s64, s4, s6
    s_mov_b32 s72, 0
    v_and_b32 v14, 15, v0
    v_lshrrev_b32 v40, 5, v0
    s_mov_b32 s75, 32768
    s_mov_b32 s76, 1
    s_mov_b32 s47, s46
    s_lshr_b32 s74, s47, 2
    s_mul_i32 s74, s74, 20
    s_and_b32 s47, s47, 3
    s_or_b32 s74, s74, s47
    s_lshl_b32 s73, s3, 2
    s_xor_b32 s73, s73, s74
    s_lshl_b32 s73, s73, 14
    s_lshl_b32 s0, s3, 14
    v_mov_b32 v164, 0
    v_mov_b32 v165, 0
    v_mov_b32 v166, 0
    v_mov_b32 v167, 0
    s_sub_u32 s1, s65, 128
    s_cmp_ge_u32 s1, 32
    s_nop 0
    s_cbranch_scc1 L_nozero
    s_lshl_b32 s47, s1, 10
    s_add_u32 s47, s47, 4718592
    buffer_store_dwordx4 v[164:167], v16, s[36:39], s47 offen sc1
    s_lshl_b32 s48, s1, 12
    s_add_u32 s48, s48, 4915200
    v_lshl_add_u32 v168, v18, 7, v16
    buffer_store_dwordx4 v[164:167], v168, s[36:39], s48 offen sc1
    buffer_store_dwordx4 v[164:167], v168, s[36:39], s48 offen offset:2048 sc1
    s_lshl_b32 s47, s1, 7
    s_add_u32 s47, s47, 4751360
    s_mov_b64 exec, 0xff
    buffer_store_dwordx4 v[164:167], v16, s[36:39], s47 offen sc1
    s_mov_b64 exec, -1
    s_branch L_nozero
L_zflag:
    s_waitcnt lgkmcnt(0)
    buffer_store_dword v41, v43, s[40:43], s1 offen sc1
    s_branch L_zback
L_nozero:
    s_nop 0
    s_waitcnt lgkmcnt(0)
    s_add_u32 s49, s16, 8192
    s_addc_u32 s50, s17, 0
    s_cmp_eq_u32 s7, 3
    s_cselect_b32 s20, s16, s20
    s_cselect_b32 s21, s17, s21
    s_cselect_b32 s22, 524288, s22
    s_cselect_b32 s24, s49, s24
    s_cselect_b32 s25, s50, s25
    s_cselect_b32 s26, 516096, s26
    s_cselect_b32 s68, 1073741824, 0
    s_movk_i32 s69, 3584
    s_cselect_b32 s69, 128, s69
    s_movk_i32 s50, 27648
    s_cselect_b32 s50, 3072, s50
    s_sub_u32 s47, s7, s6
    s_mul_i32 s70, s4, 7
    s_add_u32 s70, s70, s47
    s_mov_b32 s71, s4
    s_lshl2_add_u32 s49, s47, s3
    s_mul_i32 s47, s71, 57344
    s_lshl_b32 s48, s49, 7
    s_add_u32 s47, s47, s48
    s_lshl4_add_u32 s48, s4, s3
    s_lshl_b32 s48, s48, 10
    s_cmp_eq_u32 s7, 3
    s_cselect_b32 s47, s48, s47
    v_mul_u32_u24 v144, s69, v18
    v_lshl_add_u32 v144, v1, 4, v144
    v_add_u32 v144, s47, v144
    v_add_u32 v145, s50, v144
    s_lshl_b32 s49, s49, 17
    s_lshl_b32 s71, s71, 10
    s_add_u32 s49, s49, s71
    s_add_u32 s49, s49, 14942208
    s_add_u32 s49, s49, s68
    v_add_u32 v152, s49, v16
    s_lshl2_add_u32 s70, s70, s3
    s_lshr_b32 s47, s70, 3
    s_and_b32 s48, s70, 7
    s_lshl_b32 s49, s47, 14
    s_lshl_b32 s50, s48, 7
    s_add_u32 s49, s49, s50
    s_add_u32 s49, s49, s68
    v_lshl_add_u32 v146, v18, 10, s49
    v_lshl_add_u32 v146, v1, 4, v146
    v_add_u32 v147, 7168, v146
    s_mul_i32 s48, s48, 229376
    s_lshl_b32 s47, s47, 10
    s_add_u32 s47, s47, s48
    s_add_u32 s47, s47, 5111808
    s_add_u32 s47, s47, s68
    v_add_u32 v153, s47, v16
    s_lshl_b32 s47, s5, 1
    s_sub_u32 s47, s47, s44
    s_add_u32 s47, s47, 2
    s_and_b32 s47, s47, 7
    s_cmp_gt_u32 s47, 4
    s_cselect_b32 s47, 0, s47
    s_nop 0
    s_mov_b64 exec, 0
    s_cmp_eq_u32 s3, 0
    s_cbranch_scc1 L_pad1
    s_cmp_eq_u32 s3, 1
    s_cbranch_scc1 L_pad2
    s_cmp_eq_u32 s3, 2
    s_cbranch_scc1 L_pad1
    s_branch L_pad2
L_padret1:
    s_mov_b64 exec, -1
    s_add_u32 m0, s67, 81920
    s_nop 0
    buffer_load_dwordx4 v4, s[12:15], s52 offen  lds
    v_mov_b32 v20, 0x3f803f80
    v_mov_b32 v21, 0x3f803f80
    v_mov_b32 v22, 0x3f803f80
    v_mov_b32 v23, 0x3f803f80
    s_add_u32 s51, s51, 128
    buffer_load_dwordx4 v4, s[12:15], s52 offen offset:1024  lds
    v_mov_b32 v41, 1
    v_lshrrev_b32 v10, 1, v14
    v_xor_b32 v10, v10, v19
    v_lshlrev_b32 v10, 4, v10
    s_and_b32 s51, s51, 1023
    buffer_load_dwordx4 v5, s[12:15], s52 offen offset:2048  lds
    v_lshl_add_u32 v10, v14, 7, v10
    v_xor_b32 v11, 64, v10
    v_add_u32 v12, s66, v10
    v_add_u32 v13, s66, v11
    buffer_load_dwordx4 v5, s[12:15], s52 offen offset:3072  lds
    s_mul_i32 s52, s51, 1536
    v_bfe_u32 v168, v0, 2, 2
    v_and_b32 v169, 3, v0
    v_bfe_u32 v170, v0, 4, 1
    v_bfe_u32 v8, v0, 3, 2
    s_add_u32 m0, s66, 16384
    s_nop 0
    buffer_load_dwordx4 v2, s[8:11], s51 offen  lds
    v_xor_b32 v8, s3, v8
    v_lshlrev_b32 v8, 5, v8
    v_mul_u32_u24 v9, 2048, v19
    v_add_u32 v8, v8, v9
    buffer_load_dwordx4 v3, s[8:11], s51 offen offset:1024  lds
    v_lshl_add_u32 v8, v168, 7, v8
    v_lshl_add_u32 v8, v169, 3, v8
    v_add_u32 v8, 65536, v8
    v_add_u32 v9, 0x10000, v8
    s_add_u32 m0, s67, 98304
    s_nop 0
    buffer_load_dwordx4 v4, s[12:15], s52 offen  lds
    s_mov_b32 s54, 0x358637bd
    s_mov_b32 s55, 0x358637bd
    s_mov_b32 s56, 0x3fb8aa3b
    s_mov_b32 s57, 0x3fb8aa3b
    s_add_u32 s51, s51, 128
    buffer_load_dwordx4 v4, s[12:15], s52 offen offset:1024  lds
    s_mov_b32 s58, 0xaaaaaaaa
    s_mov_b32 s59, 0xaaaaaaaa
    s_mov_b32 s60, 0xcccccccc
    s_mov_b32 s61, 0xcccccccc
    s_and_b32 s51, s51, 1023
    buffer_load_dwordx4 v5, s[12:15], s52 offen offset:2048  lds
    s_mov_b32 s62, 0x00f0000f
    s_mov_b32 s63, 0xf0000f00
    v_lshlrev_b32 v43, 26, v0
    v_min_u32 v43, 1073741824, v43
    buffer_load_dwordx4 v5, s[12:15], s52 offen offset:3072  lds
    s_mul_i32 s52, s51, 1536
    s_waitcnt vmcnt(13)
    s_barrier
    ds_read_b64_tr_b16 v[100:101], v8 offset:0
    ds_read_b64_tr_b16 v[102:103], v8 offset:512
    ds_read_b128 a[0:3], v10 offset:0
    ds_read_b64_tr_b16 v[104:105], v8 offset:1024
    ds_read_b64_tr_b16 v[106:107], v8 offset:1536
    ds_read_b128 a[4:7], v10 offset:2048
    ds_read_b128 a[8:11], v10 offset:4096
    ds_read_b128 a[12:15], v10 offset:6144
    ds_read_b128 v[96:99], v12 offset:0
    s_waitcnt lgkmcnt(7)
    v_mfma_f32_16x16x32_bf16 v[76:79], v[20:23], v[100:103], 0
    s_add_u32 m0, s66, 24576
    s_nop 0
    buffer_load_dwordx4 v2, s[8:11], s51 offen  lds
    s_waitcnt lgkmcnt(6)
    v_mfma_f32_16x16x32_bf16 v[24:27], a[0:3], v[100:103], 0
    ds_read_b64_tr_b16 v[116:117], v8 offset:8192
    ds_read_b64_tr_b16 v[118:119], v8 offset:8704
    s_waitcnt lgkmcnt(6)
    v_mfma_f32_16x16x32_bf16 v[80:83], v[20:23], v[104:107], 0
    buffer_load_dwordx4 v3, s[8:11], s51 offen offset:1024  lds
    ds_read_b128 a[16:19], v11 offset:0
    v_mfma_f32_16x16x32_bf16 v[44:47], a[0:3], v[104:107], 0
    ds_read_b64_tr_b16 v[120:121], v8 offset:9216
    ds_read_b64_tr_b16 v[122:123], v8 offset:9728
    s_waitcnt lgkmcnt(8)
    v_mfma_f32_16x16x32_bf16 v[28:31], a[4:7], v[100:103], 0
    s_add_u32 m0, s67, 114688
    s_nop 0
    buffer_load_dwordx4 v4, s[12:15], s52 offen  lds
    v_mfma_f32_16x16x32_bf16 v[48:51], a[4:7], v[104:107], 0
    ds_read_b128 a[20:23], v11 offset:2048
    ds_read_b128 a[24:27], v11 offset:4096
    s_waitcnt lgkmcnt(9)
    v_mfma_f32_16x16x32_bf16 v[32:35], a[8:11], v[100:103], 0
    s_add_u32 s51, s51, 128
    buffer_load_dwordx4 v4, s[12:15], s52 offen offset:1024  lds
    v_mfma_f32_16x16x32_bf16 v[52:55], a[8:11], v[104:107], 0
    ds_read_b128 a[28:31], v11 offset:6144
    ds_read_b128 v[112:115], v13 offset:0
    s_waitcnt lgkmcnt(10)
    v_mfma_f32_16x16x32_bf16 v[36:39], a[12:15], v[100:103], 0
    s_and_b32 s51, s51, 1023
    buffer_load_dwordx4 v5, s[12:15], s52 offen offset:2048  lds
    v_mfma_f32_16x16x32_bf16 v[56:59], a[12:15], v[104:107], 0
    s_waitcnt lgkmcnt(9)
    v_mfma_f32_16x16x32_bf16 v[88:91], v[20:23], v[96:99], 0
    buffer_load_dwordx4 v5, s[12:15], s52 offen offset:3072  lds
    s_mul_i32 s52, s51, 1536
    v_mfma_f32_16x16x32_bf16 v[92:95], v[96:99], v[96:99], 0
    s_waitcnt vmcnt(12)
    s_waitcnt lgkmcnt(0)
    s_barrier
    s_and_b32 vcc_lo, s1, 0xffffffe3
    s_cbranch_scc0 L_zflag
L_zback:
    v_mfma_f32_16x16x32_bf16 v[76:79], v[20:23], v[116:119], v[76:79]
    s_add_u32 m0, s66, 32768
    s_nop 0
    buffer_load_dwordx4 v2, s[8:11], s51 offen  lds
    v_mfma_f32_16x16x32_bf16 v[24:27], a[16:19], v[116:119], v[24:27]
    ds_read_b64_tr_b16 v[100:101], v8 offset:16384
    ds_read_b64_tr_b16 v[102:103], v8 offset:16896
    v_mfma_f32_16x16x32_bf16 v[80:83], v[20:23], v[120:123], v[80:83]
    ds_read_b128 a[32:35], v10 offset:8192
    ds_read_b64_tr_b16 v[104:105], v8 offset:17408
    v_mfma_f32_16x16x32_bf16 v[44:47], a[16:19], v[120:123], v[44:47]
    ds_read_b64_tr_b16 v[106:107], v8 offset:17920
    ds_read_b128 a[36:39], v10 offset:10240
    v_mfma_f32_16x16x32_bf16 v[28:31], a[20:23], v[116:119], v[28:31]
    buffer_load_dwordx4 v3, s[8:11], s51 offen offset:1024  lds
    ds_read_b128 a[40:43], v10 offset:12288
    v_mfma_f32_16x16x32_bf16 v[48:51], a[20:23], v[120:123], v[48:51]
    ds_read_b128 a[44:47], v10 offset:14336
    ds_read_b128 v[96:99], v12 offset:8192
    v_mfma_f32_16x16x32_bf16 v[32:35], a[24:27], v[116:119], v[32:35]
    s_lshl_b32 s47, s47, 13
    s_mul_i32 s53, s3, 6144
    v_mfma_f32_16x16x32_bf16 v[52:55], a[24:27], v[120:123], v[52:55]
    s_add_u32 s53, s53, s47
    s_lshl_b32 s47, s3, 6
    v_mfma_f32_16x16x32_bf16 v[36:39], a[28:31], v[116:119], v[36:39]
    s_add_u32 m0, s67, 131072
    s_nop 0
    buffer_load_dwordx4 v4, s[12:15], s52 offen  lds
    v_mfma_f32_16x16x32_bf16 v[56:59], a[28:31], v[120:123], v[56:59]
    s_add_u32 s47, s47, 65536
    v_lshl_add_u32 v136, v14, 2, s47
    v_mfma_f32_16x16x32_bf16 v[88:91], v[20:23], v[112:115], v[88:91]
    v_mfma_f32_16x16x32_bf16 v[92:95], v[112:115], v[112:115], v[92:95]
    s_waitcnt lgkmcnt(0)
    s_add_u32 s51, s51, 128
    buffer_load_dwordx4 v4, s[12:15], s52 offen offset:1024  lds
    v_mfma_f32_16x16x32_bf16 v[76:79], v[20:23], v[100:103], v[76:79]
    ds_read_b64_tr_b16 v[116:117], v8 offset:24576
    ds_read_b64_tr_b16 v[118:119], v8 offset:25088
    v_mfma_f32_16x16x32_bf16 v[24:27], a[32:35], v[100:103], v[24:27]
    ds_read_b128 a[48:51], v11 offset:8192
    ds_read_b64_tr_b16 v[120:121], v8 offset:25600
    v_mfma_f32_16x16x32_bf16 v[80:83], v[20:23], v[104:107], v[80:83]
    ds_read_b64_tr_b16 v[122:123], v8 offset:26112
    ds_read_b128 a[52:55], v11 offset:10240
    v_mfma_f32_16x16x32_bf16 v[44:47], a[32:35], v[104:107], v[44:47]
    s_and_b32 s51, s51, 1023
    buffer_load_dwordx4 v5, s[12:15], s52 offen offset:2048  lds
    v_mfma_f32_16x16x32_bf16 v[28:31], a[36:39], v[100:103], v[28:31]
    ds_read_b128 a[56:59], v11 offset:12288
    ds_read_b128 a[60:63], v11 offset:14336
    v_mfma_f32_16x16x32_bf16 v[48:51], a[36:39], v[104:107], v[48:51]
    s_mov_b32 s47, 65536
    ds_read_b128 v[112:115], v13 offset:8192
    v_mfma_f32_16x16x32_bf16 v[32:35], a[40:43], v[100:103], v[32:35]
    v_lshl_add_u32 v137, v19, 4, s47
    v_lshl_add_u32 v138, v14, 2, s47
    v_mfma_f32_16x16x32_bf16 v[52:55], a[40:43], v[104:107], v[52:55]
    buffer_load_dwordx4 v5, s[12:15], s52 offen offset:3072  lds
    s_mul_i32 s52, s51, 1536
    v_mfma_f32_16x16x32_bf16 v[36:39], a[44:47], v[100:103], v[36:39]
    s_lshl_b32 s47, s6, 5
    v_and_b32 v171, 31, v0
    v_mfma_f32_16x16x32_bf16 v[56:59], a[44:47], v[104:107], v[56:59]
    s_lshr_b32 s48, s3, 1
    v_add_u32 v139, s47, v171
    v_mfma_f32_16x16x32_bf16 v[88:91], v[20:23], v[96:99], v[88:91]
    v_mfma_f32_16x16x32_bf16 v[92:95], v[96:99], v[96:99], v[92:95]
    s_waitcnt vmcnt(12)
    s_waitcnt lgkmcnt(0)
    s_barrier
    v_mfma_f32_16x16x32_bf16 v[76:79], v[20:23], v[116:119], v[76:79]
    s_add_u32 m0, s66, 40960
    s_nop 0
    buffer_load_dwordx4 v2, s[8:11], s51 offen  lds
    v_mfma_f32_16x16x32_bf16 v[24:27], a[48:51], v[116:119], v[24:27]
    ds_read_b64_tr_b16 v[100:101], v8 offset:32768
    ds_read_b64_tr_b16 v[102:103], v8 offset:33280
    v_mfma_f32_16x16x32_bf16 v[80:83], v[20:23], v[120:123], v[80:83]
    ds_read_b128 a[64:67], v10 offset:16384
    ds_read_b64_tr_b16 v[104:105], v8 offset:33792
    v_mfma_f32_16x16x32_bf16 v[44:47], a[48:51], v[120:123], v[44:47]
    ds_read_b64_tr_b16 v[106:107], v8 offset:34304
    ds_read_b128 a[68:71], v10 offset:18432
    v_mfma_f32_16x16x32_bf16 v[28:31], a[52:55], v[116:119], v[28:31]
    buffer_load_dwordx4 v3, s[8:11], s51 offen offset:1024  lds
    ds_read_b128 a[72:75], v10 offset:20480
    v_mfma_f32_16x16x32_bf16 v[48:51], a[52:55], v[120:123], v[48:51]
    ds_read_b128 a[76:79], v10 offset:22528
    ds_read_b128 v[96:99], v12 offset:16384
    v_mfma_f32_16x16x32_bf16 v[32:35], a[56:59], v[116:119], v[32:35]
    s_lshl1_add_u32 s47, s5, s48
    s_sub_u32 s47, s47, s44
    v_mfma_f32_16x16x32_bf16 v[52:55], a[56:59], v[120:123], v[52:55]
    s_and_b32 s47, s47, 7
    s_lshl_b32 s47, s47, 13
    v_mfma_f32_16x16x32_bf16 v[36:39], a[60:63], v[116:119], v[36:39]
    s_add_u32 m0, s67, 147456
    s_nop 0
    buffer_load_dwordx4 v4, s[12:15], s52 offen  lds
    v_mfma_f32_16x16x32_bf16 v[56:59], a[60:63], v[120:123], v[56:59]
    s_and_b32 s48, s3, 1
    s_lshl_b32 s48, s48, 2
    v_mfma_f32_16x16x32_bf16 v[88:91], v[20:23], v[112:115], v[88:91]
    v_mfma_f32_16x16x32_bf16 v[92:95], v[112:115], v[112:115], v[92:95]
    s_waitcnt lgkmcnt(0)
    s_add_u32 s51, s51, 128
    buffer_load_dwordx4 v4, s[12:15], s52 offen offset:1024  lds
    v_mfma_f32_16x16x32_bf16 v[76:79], v[20:23], v[100:103], v[76:79]
    ds_read_b64_tr_b16 v[116:117], v8 offset:40960
    ds_read_b64_tr_b16 v[118:119], v8 offset:41472
    v_mfma_f32_16x16x32_bf16 v[24:27], a[64:67], v[100:103], v[24:27]
    ds_read_b128 a[80:83], v11 offset:16384
    ds_read_b64_tr_b16 v[120:121], v8 offset:41984
    v_mfma_f32_16x16x32_bf16 v[80:83], v[20:23], v[104:107], v[80:83]
    ds_read_b64_tr_b16 v[122:123], v8 offset:42496
    ds_read_b128 a[84:87], v11 offset:18432
    v_mfma_f32_16x16x32_bf16 v[44:47], a[64:67], v[104:107], v[44:47]
    s_and_b32 s51, s51, 1023
    buffer_load_dwordx4 v5, s[12:15], s52 offen offset:2048  lds
    v_mfma_f32_16x16x32_bf16 v[28:31], a[68:71], v[100:103], v[28:31]
    ds_read_b128 a[88:91], v11 offset:20480
    ds_read_b128 a[92:95], v11 offset:22528
    v_mfma_f32_16x16x32_bf16 v[48:51], a[68:71], v[104:107], v[48:51]
    ds_read_b128 v[112:115], v13 offset:16384
    v_bfe_u32 v140, v139, 1, 3
    v_mfma_f32_16x16x32_bf16 v[32:35], a[72:75], v[100:103], v[32:35]
    v_xor_b32 v140, s48, v140
    v_lshlrev_b32 v140, 4, v140
    v_mfma_f32_16x16x32_bf16 v[52:55], a[72:75], v[104:107], v[52:55]
    buffer_load_dwordx4 v5, s[12:15], s52 offen offset:3072  lds
    s_mul_i32 s52, s51, 1536
    v_mfma_f32_16x16x32_bf16 v[36:39], a[76:79], v[100:103], v[36:39]
    v_lshl_add_u32 v140, v139, 7, v140
    v_lshl_add_u32 v140, v40, 3, v140
    v_mfma_f32_16x16x32_bf16 v[56:59], a[76:79], v[104:107], v[56:59]
    v_add_u32 v140, s47, v140
    v_xor_b32 v141, 16, v140
    v_mfma_f32_16x16x32_bf16 v[88:91], v[20:23], v[96:99], v[88:91]
    v_mfma_f32_16x16x32_bf16 v[92:95], v[96:99], v[96:99], v[92:95]
    s_waitcnt vmcnt(12)
    s_waitcnt lgkmcnt(0)
    s_barrier
    v_mfma_f32_16x16x32_bf16 v[76:79], v[20:23], v[116:119], v[76:79]
    s_add_u32 m0, s66, 49152
    s_nop 0
    buffer_load_dwordx4 v2, s[8:11], s51 offen  lds
    v_mfma_f32_16x16x32_bf16 v[24:27], a[80:83], v[116:119], v[24:27]
    ds_read_b64_tr_b16 v[100:101], v8 offset:49152
    ds_read_b64_tr_b16 v[102:103], v8 offset:49664
    v_mfma_f32_16x16x32_bf16 v[80:83], v[20:23], v[120:123], v[80:83]
    ds_read_b128 a[96:99], v10 offset:24576
    ds_read_b64_tr_b16 v[104:105], v8 offset:50176
    v_mfma_f32_16x16x32_bf16 v[44:47], a[80:83], v[120:123], v[44:47]
    ds_read_b64_tr_b16 v[106:107], v8 offset:50688
    ds_read_b128 a[100:103], v10 offset:26624
    v_mfma_f32_16x16x32_bf16 v[28:31], a[84:87], v[116:119], v[28:31]
    buffer_load_dwordx4 v3, s[8:11], s51 offen offset:1024  lds
    ds_read_b128 a[104:107], v10 offset:28672
    v_mfma_f32_16x16x32_bf16 v[48:51], a[84:87], v[120:123], v[48:51]
    ds_read_b128 a[108:111], v10 offset:30720
    ds_read_b128 v[96:99], v12 offset:24576
    v_mfma_f32_16x16x32_bf16 v[32:35], a[88:91], v[116:119], v[32:35]
    v_xor_b32 v142, 32, v140
    v_xor_b32 v143, 48, v140
    v_mfma_f32_16x16x32_bf16 v[52:55], a[88:91], v[120:123], v[52:55]
    v_lshlrev_b32 v139, 2, v139
    v_add_u32 v139, 65792, v139
    v_mfma_f32_16x16x32_bf16 v[36:39], a[92:95], v[116:119], v[36:39]
    s_add_u32 m0, s67, 65536
    s_nop 0
    buffer_load_dwordx4 v4, s[12:15], s52 offen  lds
    v_mfma_f32_16x16x32_bf16 v[56:59], a[92:95], v[120:123], v[56:59]
    s_add_u32 s50, s53, 0
    v_lshl_add_u32 v150, v40, 2, v168
    v_mfma_f32_16x16x32_bf16 v[88:91], v[20:23], v[112:115], v[88:91]
    v_mfma_f32_16x16x32_bf16 v[92:95], v[112:115], v[112:115], v[92:95]
    s_waitcnt lgkmcnt(0)
    s_add_u32 s51, s51, 128
    buffer_load_dwordx4 v4, s[12:15], s52 offen offset:1024  lds
    v_mfma_f32_16x16x32_bf16 v[76:79], v[20:23], v[100:103], v[76:79]
    ds_read_b64_tr_b16 v[116:117], v8 offset:57344
    ds_read_b64_tr_b16 v[118:119], v8 offset:57856
    v_mfma_f32_16x16x32_bf16 v[24:27], a[96:99], v[100:103], v[24:27]
    ds_read_b128 a[112:115], v11 offset:24576
    ds_read_b64_tr_b16 v[120:121], v8 offset:58368
    v_mfma_f32_16x16x32_bf16 v[80:83], v[20:23], v[104:107], v[80:83]
L_pad1:
    s_cbranch_execz L_padret1
    ds_read_b64_tr_b16 v[122:123], v8 offset:58880
    ds_read_b128 a[116:119], v11 offset:26624
    v_mfma_f32_16x16x32_bf16 v[44:47], a[96:99], v[104:107], v[44:47]
    s_and_b32 s51, s51, 1023
    buffer_load_dwordx4 v5, s[12:15], s52 offen offset:2048  lds
    v_mfma_f32_16x16x32_bf16 v[28:31], a[100:103], v[100:103], v[28:31]
    ds_read_b128 a[120:123], v11 offset:28672
    ds_read_b128 a[124:127], v11 offset:30720
    v_mfma_f32_16x16x32_bf16 v[48:51], a[100:103], v[104:107], v[48:51]
    ds_read_b128 v[112:115], v13 offset:24576
    v_lshl_add_u32 v150, v150, 7, s50
    v_mfma_f32_16x16x32_bf16 v[32:35], a[104:107], v[100:103], v[32:35]
    v_lshl_add_u32 v150, v169, 3, v150
    v_lshl_add_u32 v151, v170, 5, v150
    v_mfma_f32_16x16x32_bf16 v[52:55], a[104:107], v[104:107], v[52:55]
    buffer_load_dwordx4 v5, s[12:15], s52 offen offset:3072  lds
    s_mul_i32 s52, s51, 1536
    v_mfma_f32_16x16x32_bf16 v[36:39], a[108:111], v[100:103], v[36:39]
    v_lshl_add_u32 v150, v170, 11, v150
    v_lshl_add_u32 v151, v40, 9, v151
    v_mfma_f32_16x16x32_bf16 v[56:59], a[108:111], v[104:107], v[56:59]
    v_lshl_add_u32 v253, v168, 10, s50
    v_lshl_add_u32 v253, v169, 4, v253
    v_mfma_f32_16x16x32_bf16 v[88:91], v[20:23], v[96:99], v[88:91]
    v_mfma_f32_16x16x32_bf16 v[92:95], v[96:99], v[96:99], v[92:95]
    s_waitcnt vmcnt(12)
    s_waitcnt lgkmcnt(0)
    s_barrier
    v_mfma_f32_16x16x32_bf16 v[76:79], v[20:23], v[116:119], v[76:79]
    s_add_u32 m0, s66, 57344
    s_nop 0
    buffer_load_dwordx4 v2, s[8:11], s51 offen  lds
    v_mfma_f32_16x16x32_bf16 v[24:27], a[112:115], v[116:119], v[24:27]
    ds_read_b64_tr_b16 v[100:101], v9 offset:0
    ds_read_b64_tr_b16 v[102:103], v9 offset:512
    v_mfma_f32_16x16x32_bf16 v[80:83], v[20:23], v[120:123], v[80:83]
    ds_read_b128 a[128:131], v10 offset:32768
    ds_read_b64_tr_b16 v[104:105], v9 offset:1024
    v_mfma_f32_16x16x32_bf16 v[44:47], a[112:115], v[120:123], v[44:47]
    ds_read_b64_tr_b16 v[106:107], v9 offset:1536
    ds_read_b128 a[132:135], v10 offset:34816
    v_mfma_f32_16x16x32_bf16 v[28:31], a[116:119], v[116:119], v[28:31]
    buffer_load_dwordx4 v3, s[8:11], s51 offen offset:1024  lds
    ds_read_b128 a[136:139], v10 offset:36864
    v_mfma_f32_16x16x32_bf16 v[48:51], a[116:119], v[120:123], v[48:51]
    ds_read_b128 a[140:143], v10 offset:38912
    ds_read_b128 v[96:99], v12 offset:32768
    v_mfma_f32_16x16x32_bf16 v[32:35], a[120:123], v[116:119], v[32:35]
    s_lshl_b32 s47, s4, 7
    v_lshl_add_u32 v253, v19, 6, v253
    v_mfma_f32_16x16x32_bf16 v[52:55], a[120:123], v[120:123], v[52:55]
    s_and_b32 s48, s3, 1
    s_lshl4_add_u32 s47, s48, s47
    v_mfma_f32_16x16x32_bf16 v[36:39], a[124:127], v[116:119], v[36:39]
    s_add_u32 m0, s67, 81920
    s_nop 0
    buffer_load_dwordx4 v4, s[12:15], s52 offen  lds
    v_mfma_f32_16x16x32_bf16 v[56:59], a[124:127], v[120:123], v[56:59]
    s_lshr_b32 s48, s3, 1
    s_lshl3_add_u32 s47, s48, s47
    v_mfma_f32_16x16x32_bf16 v[88:91], v[20:23], v[112:115], v[88:91]
    v_mfma_f32_16x16x32_bf16 v[92:95], v[112:115], v[112:115], v[92:95]
    s_waitcnt lgkmcnt(0)
    s_add_u32 s51, s51, 128
    buffer_load_dwordx4 v4, s[12:15], s52 offen offset:1024  lds
    v_mfma_f32_16x16x32_bf16 v[76:79], v[20:23], v[100:103], v[76:79]
    ds_read_b64_tr_b16 v[116:117], v9 offset:8192
    ds_read_b64_tr_b16 v[118:119], v9 offset:8704
    v_mfma_f32_16x16x32_bf16 v[24:27], a[128:131], v[100:103], v[24:27]
    ds_read_b128 a[144:147], v11 offset:32768
    ds_read_b64_tr_b16 v[120:121], v9 offset:9216
    v_mfma_f32_16x16x32_bf16 v[80:83], v[20:23], v[104:107], v[80:83]
    ds_read_b64_tr_b16 v[122:123], v9 offset:9728
    ds_read_b128 a[148:151], v11 offset:34816
    v_mfma_f32_16x16x32_bf16 v[44:47], a[128:131], v[104:107], v[44:47]
    s_and_b32 s51, s51, 1023
    buffer_load_dwordx4 v5, s[12:15], s52 offen offset:2048  lds
    v_mfma_f32_16x16x32_bf16 v[28:31], a[132:135], v[100:103], v[28:31]
    ds_read_b128 a[152:155], v11 offset:36864
    ds_read_b128 a[156:159], v11 offset:38912
    v_mfma_f32_16x16x32_bf16 v[48:51], a[132:135], v[104:107], v[48:51]
    s_add_u32 s47, s47, 4751424
    ds_read_b128 v[112:115], v13 offset:32768
    v_mfma_f32_16x16x32_bf16 v[32:35], a[136:139], v[100:103], v[32:35]
    s_lshl2_add_u32 s70, s7, s3
    v_add_u32 v254, s47, v43
    v_mfma_f32_16x16x32_bf16 v[52:55], a[136:139], v[104:107], v[52:55]
    buffer_load_dwordx4 v5, s[12:15], s52 offen offset:3072  lds
    s_mul_i32 s52, s51, 1536
    v_mfma_f32_16x16x32_bf16 v[36:39], a[140:143], v[100:103], v[36:39]
    s_lshl_b32 s47, s70, 10
    s_add_u32 s48, s47, 4718592
    v_mfma_f32_16x16x32_bf16 v[56:59], a[140:143], v[104:107], v[56:59]
    v_bfe_u32 v148, v0, 2, 1
    v_lshl_add_u32 v148, v148, 9, s48
    v_mfma_f32_16x16x32_bf16 v[88:91], v[20:23], v[96:99], v[88:91]
    v_mfma_f32_16x16x32_bf16 v[92:95], v[96:99], v[96:99], v[92:95]
    s_waitcnt vmcnt(12)
    s_waitcnt lgkmcnt(0)
    s_barrier
    v_mfma_f32_16x16x32_bf16 v[76:79], v[20:23], v[116:119], v[76:79]
    s_add_u32 m0, s67, 98304
    s_add_u32 s51, s51, 128
    v_mfma_f32_16x16x32_bf16 v[24:27], a[144:147], v[116:119], v[24:27]
    buffer_load_dwordx4 v6, s[12:15], s52 offen  lds
    ds_read_b64_tr_b16 v[100:101], v9 offset:16384
    v_mfma_f32_16x16x32_bf16 v[80:83], v[20:23], v[120:123], v[80:83]
    ds_read_b64_tr_b16 v[102:103], v9 offset:16896
    ds_read_b128 a[160:163], v10 offset:40960
    v_mfma_f32_16x16x32_bf16 v[44:47], a[144:147], v[120:123], v[44:47]
    ds_read_b64_tr_b16 v[104:105], v9 offset:17408
    ds_read_b64_tr_b16 v[106:107], v9 offset:17920
    v_mfma_f32_16x16x32_bf16 v[28:31], a[148:151], v[116:119], v[28:31]
    s_and_b32 s51, s51, 1023
    buffer_load_dwordx4 v7, s[12:15], s52 offen offset:2048  lds
    v_mfma_f32_16x16x32_bf16 v[48:51], a[148:151], v[120:123], v[48:51]
    ds_read_b128 a[164:167], v10 offset:43008
    ds_read_b128 a[168:171], v10 offset:45056
    v_mfma_f32_16x16x32_bf16 v[32:35], a[152:155], v[116:119], v[32:35]
    ds_read_b128 a[172:175], v10 offset:47104
    ds_read_b128 v[96:99], v12 offset:40960
    v_mfma_f32_16x16x32_bf16 v[52:55], a[152:155], v[120:123], v[52:55]
    v_bfe_u32 v149, v0, 3, 1
    v_lshl_add_u32 v148, v149, 6, v148
    v_mfma_f32_16x16x32_bf16 v[36:39], a[156:159], v[116:119], v[36:39]
    s_mul_i32 s52, s51, 1536
    s_add_u32 m0, s67, 99328
    v_mfma_f32_16x16x32_bf16 v[56:59], a[156:159], v[120:123], v[56:59]
    s_add_u32 s51, s51, 128
    buffer_load_dwordx4 v6, s[12:15], s52 offen  lds
    v_mfma_f32_16x16x32_bf16 v[88:91], v[20:23], v[112:115], v[88:91]
    v_lshl_add_u32 v148, v169, 2, v148
    v_lshl_add_u32 v148, v19, 4, v148
    v_mfma_f32_16x16x32_bf16 v[92:95], v[112:115], v[112:115], v[92:95]
    s_lshl_b32 s48, s70, 7
    s_add_u32 s48, s48, 4751360
    s_waitcnt lgkmcnt(0)
    s_and_b32 s51, s51, 1023
    buffer_load_dwordx4 v7, s[12:15], s52 offen offset:2048  lds
    v_mfma_f32_16x16x32_bf16 v[76:79], v[20:23], v[100:103], v[76:79]
    ds_read_b64_tr_b16 v[116:117], v9 offset:24576
    ds_read_b64_tr_b16 v[118:119], v9 offset:25088
    v_mfma_f32_16x16x32_bf16 v[24:27], a[160:163], v[100:103], v[24:27]
    ds_read_b128 a[176:179], v11 offset:40960
    ds_read_b64_tr_b16 v[120:121], v9 offset:25600
    v_mfma_f32_16x16x32_bf16 v[80:83], v[20:23], v[104:107], v[80:83]
    ds_read_b64_tr_b16 v[122:123], v9 offset:26112
    ds_read_b128 a[180:183], v11 offset:43008
    v_mfma_f32_16x16x32_bf16 v[44:47], a[160:163], v[104:107], v[44:47]
    s_mul_i32 s52, s51, 1536
    s_add_u32 m0, s67, 114688
    v_mfma_f32_16x16x32_bf16 v[28:31], a[164:167], v[100:103], v[28:31]
    s_add_u32 s51, s51, 128
    buffer_load_dwordx4 v6, s[12:15], s52 offen  lds
    v_mfma_f32_16x16x32_bf16 v[48:51], a[164:167], v[104:107], v[48:51]
    ds_read_b128 a[184:187], v11 offset:45056
    ds_read_b128 a[188:191], v11 offset:47104
    v_mfma_f32_16x16x32_bf16 v[32:35], a[168:171], v[100:103], v[32:35]
    ds_read_b128 v[112:115], v13 offset:40960
    v_lshl_add_u32 v149, v19, 28, v17
    v_mfma_f32_16x16x32_bf16 v[52:55], a[168:171], v[104:107], v[52:55]
    s_and_b32 s51, s51, 1023
    buffer_load_dwordx4 v7, s[12:15], s52 offen offset:2048  lds
    v_mfma_f32_16x16x32_bf16 v[36:39], a[172:175], v[100:103], v[36:39]
    s_mul_i32 s52, s51, 1536
    v_add_u32 v149, s48, v149
    v_mfma_f32_16x16x32_bf16 v[56:59], a[172:175], v[104:107], v[56:59]
    s_mul_i32 s48, s4, 67584
    s_add_u32 s47, s47, s48
    v_mfma_f32_16x16x32_bf16 v[88:91], v[20:23], v[96:99], v[88:91]
    v_add_u32 v154, s47, v16
    v_add_u32 v155, 33792, v154
    v_mfma_f32_16x16x32_bf16 v[92:95], v[96:99], v[96:99], v[92:95]
    s_lshl_b32 s47, s5, 8
    s_waitcnt vmcnt(12)
    s_waitcnt lgkmcnt(0)
    s_barrier
    v_mfma_f32_16x16x32_bf16 v[76:79], v[20:23], v[116:119], v[76:79]
    s_add_u32 m0, s67, 115712
    s_add_u32 s51, s51, 128
    v_mfma_f32_16x16x32_bf16 v[24:27], a[176:179], v[116:119], v[24:27]
    buffer_load_dwordx4 v6, s[12:15], s52 offen  lds
    ds_read_b64_tr_b16 v[100:101], v8 offset:0
    v_mfma_f32_16x16x32_bf16 v[80:83], v[20:23], v[120:123], v[80:83]
    ds_read_b64_tr_b16 v[102:103], v8 offset:512
    ds_read_b128 a[192:195], v10 offset:49152
    v_mfma_f32_16x16x32_bf16 v[44:47], a[176:179], v[120:123], v[44:47]
    s_and_b32 s51, s51, 1023
    buffer_load_dwordx4 v7, s[12:15], s52 offen offset:2048  lds
    v_mfma_f32_16x16x32_bf16 v[28:31], a[180:183], v[116:119], v[28:31]
    ds_read_b64_tr_b16 v[104:105], v8 offset:1024
    ds_read_b64_tr_b16 v[106:107], v8 offset:1536
    v_mfma_f32_16x16x32_bf16 v[48:51], a[180:183], v[120:123], v[48:51]
    ds_read_b128 a[196:199], v10 offset:51200
    ds_read_b128 a[200:203], v10 offset:53248
    v_mfma_f32_16x16x32_bf16 v[32:35], a[184:187], v[116:119], v[32:35]
    ds_read_b128 a[204:207], v10 offset:55296
    ds_read_b128 v[96:99], v12 offset:49152
    v_mfma_f32_16x16x32_bf16 v[52:55], a[184:187], v[120:123], v[52:55]
    s_mul_i32 s52, s51, 1536
    s_add_u32 m0, s67, 131072
    v_mfma_f32_16x16x32_bf16 v[36:39], a[188:191], v[116:119], v[36:39]
    s_add_u32 s51, s51, 128
    buffer_load_dwordx4 v6, s[12:15], s52 offen  lds
    v_mfma_f32_16x16x32_bf16 v[56:59], a[188:191], v[120:123], v[56:59]
    v_lshl_add_u32 v156, v19, 10, s47
    v_lshl_add_u32 v156, v14, 4, v156
    v_mfma_f32_16x16x32_bf16 v[88:91], v[20:23], v[112:115], v[88:91]
    s_and_b32 s51, s51, 1023
    buffer_load_dwordx4 v7, s[12:15], s52 offen offset:2048  lds
    v_mfma_f32_16x16x32_bf16 v[92:95], v[112:115], v[112:115], v[92:95]
    s_waitcnt lgkmcnt(0)
    v_xor_b32 v157, 64, v156
    v_add_u32 v157, 3072, v157
    v_mfma_f32_16x16x32_bf16 v[76:79], v[20:23], v[100:103], v[76:79]
    ds_read_b64_tr_b16 v[116:117], v8 offset:8192
    ds_read_b64_tr_b16 v[118:119], v8 offset:8704
    v_mfma_f32_16x16x32_bf16 v[24:27], a[192:195], v[100:103], v[24:27]
    s_mul_i32 s52, s51, 1536
    s_add_u32 m0, s67, 132096
    v_mfma_f32_16x16x32_bf16 v[80:83], v[20:23], v[104:107], v[80:83]
    s_add_u32 s51, s51, 128
    buffer_load_dwordx4 v6, s[12:15], s52 offen  lds
    v_mfma_f32_16x16x32_bf16 v[44:47], a[192:195], v[104:107], v[44:47]
    ds_read_b128 a[208:211], v11 offset:49152
    ds_read_b64_tr_b16 v[120:121], v8 offset:9216
    v_mfma_f32_16x16x32_bf16 v[28:31], a[196:199], v[100:103], v[28:31]
    s_and_b32 s51, s51, 1023
    buffer_load_dwordx4 v7, s[12:15], s52 offen offset:2048  lds
    v_mfma_f32_16x16x32_bf16 v[48:51], a[196:199], v[104:107], v[48:51]
    ds_read_b64_tr_b16 v[122:123], v8 offset:9728
    ds_read_b128 a[212:215], v11 offset:51200
    v_mfma_f32_16x16x32_bf16 v[32:35], a[200:203], v[100:103], v[32:35]
    ds_read_b128 a[216:219], v11 offset:53248
    ds_read_b128 a[220:223], v11 offset:55296
    v_mfma_f32_16x16x32_bf16 v[52:55], a[200:203], v[104:107], v[52:55]
    ds_read_b128 v[112:115], v13 offset:49152
    v_xor_b32 v158, 128, v156
    v_mfma_f32_16x16x32_bf16 v[36:39], a[204:207], v[100:103], v[36:39]
    s_mul_i32 s52, s51, 1536
    buffer_load_dword v171, v17, s[40:43], 0 offen sc1
    v_mfma_f32_16x16x32_bf16 v[56:59], a[204:207], v[104:107], v[56:59]
    v_add_u32 v158, 6144, v158
    v_xor_b32 v159, 192, v156
    v_mfma_f32_16x16x32_bf16 v[88:91], v[20:23], v[96:99], v[88:91]
    v_add_u32 v159, 9216, v159
    v_mfma_f32_16x16x32_bf16 v[92:95], v[96:99], v[96:99], v[92:95]
    s_waitcnt vmcnt(13)
    s_waitcnt lgkmcnt(0)
    s_barrier
    v_mfma_f32_16x16x32_bf16 v[76:79], v[20:23], v[116:119], v[76:79]
    s_add_u32 m0, s67, 147456
    s_add_u32 s51, s51, 128
    v_mfma_f32_16x16x32_bf16 v[24:27], a[208:211], v[116:119], v[24:27]
    buffer_load_dwordx4 v6, s[12:15], s52 offen  lds
    ds_read_b64_tr_b16 v[100:101], v8 offset:16384
    v_mfma_f32_16x16x32_bf16 v[80:83], v[20:23], v[120:123], v[80:83]
    ds_read_b64_tr_b16 v[102:103], v8 offset:16896
    ds_read_b128 a[224:227], v10 offset:57344
    v_mfma_f32_16x16x32_bf16 v[44:47], a[208:211], v[120:123], v[44:47]
    ds_read_b64_tr_b16 v[104:105], v8 offset:17408
    ds_read_b64_tr_b16 v[106:107], v8 offset:17920
    v_mfma_f32_16x16x32_bf16 v[28:31], a[212:215], v[116:119], v[28:31]
    s_and_b32 s51, s51, 1023
    buffer_load_dwordx4 v7, s[12:15], s52 offen offset:2048  lds
    v_mfma_f32_16x16x32_bf16 v[48:51], a[212:215], v[120:123], v[48:51]
    ds_read_b128 a[228:231], v10 offset:59392
    ds_read_b128 a[232:235], v10 offset:61440
    v_mfma_f32_16x16x32_bf16 v[32:35], a[216:219], v[116:119], v[32:35]
    ds_read_b128 a[236:239], v10 offset:63488
    ds_read_b128 v[96:99], v12 offset:57344
    v_mfma_f32_16x16x32_bf16 v[52:55], a[216:219], v[120:123], v[52:55]
    v_mfma_f32_16x16x32_bf16 v[36:39], a[220:223], v[116:119], v[36:39]
    s_mul_i32 s52, s51, 1536
    s_add_u32 m0, s67, 148480
    v_mfma_f32_16x16x32_bf16 v[56:59], a[220:223], v[120:123], v[56:59]
    s_add_u32 s51, s51, 128
    buffer_load_dwordx4 v6, s[12:15], s52 offen  lds
    v_mfma_f32_16x16x32_bf16 v[88:91], v[20:23], v[112:115], v[88:91]
    v_mfma_f32_16x16x32_bf16 v[92:95], v[112:115], v[112:115], v[92:95]
    s_waitcnt lgkmcnt(0)
    s_and_b32 s51, s51, 1023
    buffer_load_dwordx4 v7, s[12:15], s52 offen offset:2048  lds
    v_mfma_f32_16x16x32_bf16 v[76:79], v[20:23], v[100:103], v[76:79]
    ds_read_b64_tr_b16 v[116:117], v8 offset:24576
    ds_read_b64_tr_b16 v[118:119], v8 offset:25088
    v_mfma_f32_16x16x32_bf16 v[24:27], a[224:227], v[100:103], v[24:27]
    ds_read_b128 a[240:243], v11 offset:57344
    ds_read_b64_tr_b16 v[120:121], v8 offset:25600
    v_mfma_f32_16x16x32_bf16 v[80:83], v[20:23], v[104:107], v[80:83]
    ds_read_b64_tr_b16 v[122:123], v8 offset:26112
    ds_read_b128 a[244:247], v11 offset:59392
    v_mfma_f32_16x16x32_bf16 v[44:47], a[224:227], v[104:107], v[44:47]
    s_mul_i32 s52, s51, 1536
    s_mov_b32 m0, s53
    v_mfma_f32_16x16x32_bf16 v[28:31], a[228:231], v[100:103], v[28:31]
    buffer_load_dwordx4 v144, s[20:23], 0 offen  lds
    ds_read_b128 a[248:251], v11 offset:61440
    v_mfma_f32_16x16x32_bf16 v[48:51], a[228:231], v[104:107], v[48:51]
    ds_read_b128 a[252:255], v11 offset:63488
    ds_read_b128 v[112:115], v13 offset:57344
    v_mfma_f32_16x16x32_bf16 v[32:35], a[232:235], v[100:103], v[32:35]
    ds_read_b64 v[128:129], v140
    ds_read_b64 v[130:131], v141
    v_mfma_f32_16x16x32_bf16 v[52:55], a[232:235], v[104:107], v[52:55]
    buffer_load_dwordx4 v145, s[20:23], 0 offen offset:1024  lds
    ds_read_b64 v[132:133], v142
    v_mfma_f32_16x16x32_bf16 v[36:39], a[236:239], v[100:103], v[36:39]
    ds_read_b64 v[134:135], v143
    v_mfma_f32_16x16x32_bf16 v[56:59], a[236:239], v[104:107], v[56:59]
    v_mfma_f32_16x16x32_bf16 v[88:91], v[20:23], v[96:99], v[88:91]
    v_mfma_f32_16x16x32_bf16 v[92:95], v[96:99], v[96:99], v[92:95]
    s_waitcnt lgkmcnt(0)
    v_mfma_f32_16x16x32_bf16 v[88:91], v[20:23], v[112:115], v[88:91]
    s_add_u32 m0, s53, 2048
    s_nop 0
    buffer_load_dwordx4 v144, s[24:27], 0 offen  lds
    v_mfma_f32_16x16x32_bf16 v[92:95], v[112:115], v[112:115], v[92:95]
    v_mfma_f32_16x16x32_bf16 v[76:79], v[20:23], v[116:119], v[76:79]
    v_mfma_f32_16x16x32_bf16 v[24:27], a[240:243], v[116:119], v[24:27]
    v_mfma_f32_16x16x32_bf16 v[80:83], v[20:23], v[120:123], v[80:83]
    v_mfma_f32_16x16x32_bf16 v[44:47], a[240:243], v[120:123], v[44:47]
    v_mul_f32 v162, 0x3b000000, v88
    s_nop 2
    v_cndmask_b32 v161, v92, v93, s[58:59]
    v_mfma_f32_16x16x32_bf16 v[28:31], a[244:247], v[116:119], v[28:31]
    v_cndmask_b32 v168, v94, v95, s[58:59]
    v_mul_f32 v169, v162, v162
    v_mfma_f32_16x16x32_bf16 v[48:51], a[244:247], v[120:123], v[48:51]
    v_cndmask_b32 v161, v161, v168, s[60:61]
    v_subrev_f32 v169, 0x3727c5ac, v169
    v_mfma_f32_16x16x32_bf16 v[32:35], a[248:251], v[116:119], v[32:35]
    v_mul_f32 v161, 0x3b000000, v161
    v_sub_f32 v161, v161, v169
    v_mfma_f32_16x16x32_bf16 v[52:55], a[248:251], v[120:123], v[52:55]
    v_max_f32 v161, 0x3727c5ac, v161
    v_mfma_f32_16x16x32_bf16 v[36:39], a[252:255], v[116:119], v[36:39]
    v_rsq_f32 v161, v161
    v_mfma_f32_16x16x32_bf16 v[56:59], a[252:255], v[120:123], v[56:59]
    s_mov_b64 exec, s[62:63]
    ds_write2_b32 v136, v161, v162 offset0:0 offset1:64
    s_mov_b64 exec, -1
    s_waitcnt vmcnt(7)
    v_cmp_gt_u32 vcc, 1, v171
    s_nop 0
    s_and_b32 vcc_lo, vcc_lo, 0xff
    s_cbranch_scc1 L_rare2
L_back2:
    s_waitcnt lgkmcnt(0)
    s_barrier
    ds_read_b128 v[192:195], v137 offset:256
    ds_read_b128 v[176:179], v137 offset:0
    ds_read_b128 v[196:199], v137 offset:320
    ds_read_b128 v[180:183], v137 offset:64
    ds_read_b128 v[200:203], v137 offset:384
    ds_read_b128 v[184:187], v137 offset:128
    ds_read_b128 v[204:207], v137 offset:448
    ds_read_b128 v[188:191], v137 offset:192
    s_waitcnt lgkmcnt(7)
    v_pk_fma_f32 v[24:25], v[192:193], v[76:77], v[24:25] neg_lo:[1,0,0] neg_hi:[1,0,0]
    buffer_load_dwordx4 v145, s[24:27], 0 offen offset:1024  lds
    v_pk_fma_f32 v[44:45], v[192:193], v[80:81], v[44:45] neg_lo:[1,0,0] neg_hi:[1,0,0]
    s_waitcnt lgkmcnt(6)
    v_pk_fma_f32 v[24:25], v[24:25], v[176:177], s[54:55]
    v_pk_mul_f32 v[44:45], v[44:45], v[176:177]
    v_pk_mul_f32 v[208:209], v[24:25], s[56:57]
    v_max_f32 v24, s54, v24
    v_exp_f32 v208, v208 clamp
    v_exp_f32 v209, v209 clamp
    v_max_f32 v25, s54, v25
    v_cvt_pk_bf16_f32 v104, v44, v45
    v_pk_add_f32 v[24:25], v[24:25], v[208:209]
    s_add_u32 m0, s53, 4096
    s_nop 0
    buffer_load_dwordx4 v146, s[28:31], 0 offen  lds
    v_cvt_pk_bf16_f32 v96, v24, v25
    v_pk_fma_f32 v[26:27], v[194:195], v[76:77], v[26:27] neg_lo:[1,0,0] neg_hi:[1,0,0]
    v_pk_fma_f32 v[46:47], v[194:195], v[80:81], v[46:47] neg_lo:[1,0,0] neg_hi:[1,0,0]
    v_pk_fma_f32 v[26:27], v[26:27], v[178:179], s[54:55]
    v_pk_mul_f32 v[46:47], v[46:47], v[178:179]
    v_pk_mul_f32 v[208:209], v[26:27], s[56:57]
    v_max_f32 v26, s54, v26
    v_exp_f32 v208, v208 clamp
    v_exp_f32 v209, v209 clamp
    v_max_f32 v27, s54, v27
    buffer_load_dwordx4 v147, s[28:31], 0 offen offset:1024  lds
    v_cvt_pk_bf16_f32 v105, v46, v47
    v_pk_add_f32 v[26:27], v[26:27], v[208:209]
    v_cvt_pk_bf16_f32 v97, v26, v27
    s_waitcnt lgkmcnt(5)
    v_pk_fma_f32 v[28:29], v[196:197], v[76:77], v[28:29] neg_lo:[1,0,0] neg_hi:[1,0,0]
    v_pk_fma_f32 v[48:49], v[196:197], v[80:81], v[48:49] neg_lo:[1,0,0] neg_hi:[1,0,0]
    s_waitcnt lgkmcnt(4)
    v_pk_fma_f32 v[28:29], v[28:29], v[180:181], s[54:55]
    v_pk_mul_f32 v[48:49], v[48:49], v[180:181]
    v_pk_mul_f32 v[208:209], v[28:29], s[56:57]
    v_max_f32 v28, s54, v28
    v_exp_f32 v208, v208 clamp
    v_exp_f32 v209, v209 clamp
    v_max_f32 v29, s54, v29
    v_cvt_pk_bf16_f32 v106, v48, v49
    v_pk_add_f32 v[28:29], v[28:29], v[208:209]
    v_cvt_pk_bf16_f32 v98, v28, v29
    v_pk_fma_f32 v[30:31], v[198:199], v[76:77], v[30:31] neg_lo:[1,0,0] neg_hi:[1,0,0]
    v_pk_fma_f32 v[50:51], v[198:199], v[80:81], v[50:51] neg_lo:[1,0,0] neg_hi:[1,0,0]
    v_pk_fma_f32 v[30:31], v[30:31], v[182:183], s[54:55]
    v_pk_mul_f32 v[50:51], v[50:51], v[182:183]
    v_pk_mul_f32 v[208:209], v[30:31], s[56:57]
    v_max_f32 v30, s54, v30
    v_exp_f32 v208, v208 clamp
    v_exp_f32 v209, v209 clamp
    v_max_f32 v31, s54, v31
    v_cvt_pk_bf16_f32 v107, v50, v51
    v_pk_add_f32 v[30:31], v[30:31], v[208:209]
    v_cvt_pk_bf16_f32 v99, v30, v31
    s_waitcnt lgkmcnt(3)
    v_pk_fma_f32 v[32:33], v[200:201], v[76:77], v[32:33] neg_lo:[1,0,0] neg_hi:[1,0,0]
    v_pk_fma_f32 v[52:53], v[200:201], v[80:81], v[52:53] neg_lo:[1,0,0] neg_hi:[1,0,0]
    s_waitcnt lgkmcnt(2)
    v_pk_fma_f32 v[32:33], v[32:33], v[184:185], s[54:55]
    v_pk_mul_f32 v[52:53], v[52:53], v[184:185]
    v_pk_mul_f32 v[208:209], v[32:33], s[56:57]
    v_max_f32 v32, s54, v32
    v_exp_f32 v208, v208 clamp
    v_exp_f32 v209, v209 clamp
    v_max_f32 v33, s54, v33
    v_cvt_pk_bf16_f32 v108, v52, v53
    v_pk_add_f32 v[32:33], v[32:33], v[208:209]
    v_cvt_pk_bf16_f32 v100, v32, v33
    v_pk_fma_f32 v[34:35], v[202:203], v[76:77], v[34:35] neg_lo:[1,0,0] neg_hi:[1,0,0]
    v_pk_fma_f32 v[54:55], v[202:203], v[80:81], v[54:55] neg_lo:[1,0,0] neg_hi:[1,0,0]
    v_pk_fma_f32 v[34:35], v[34:35], v[186:187], s[54:55]
    v_pk_mul_f32 v[54:55], v[54:55], v[186:187]
    v_pk_mul_f32 v[208:209], v[34:35], s[56:57]
    v_max_f32 v34, s54, v34
    v_exp_f32 v208, v208 clamp
    v_exp_f32 v209, v209 clamp
    v_max_f32 v35, s54, v35
    v_cvt_pk_bf16_f32 v109, v54, v55
    v_pk_add_f32 v[34:35], v[34:35], v[208:209]
    v_cvt_pk_bf16_f32 v101, v34, v35
    s_waitcnt lgkmcnt(1)
    v_pk_fma_f32 v[36:37], v[204:205], v[76:77], v[36:37] neg_lo:[1,0,0] neg_hi:[1,0,0]
    v_pk_fma_f32 v[56:57], v[204:205], v[80:81], v[56:57] neg_lo:[1,0,0] neg_hi:[1,0,0]
    s_waitcnt lgkmcnt(0)
    v_pk_fma_f32 v[36:37], v[36:37], v[188:189], s[54:55]
    v_pk_mul_f32 v[56:57], v[56:57], v[188:189]
    v_pk_mul_f32 v[208:209], v[36:37], s[56:57]
    v_max_f32 v36, s54, v36
    v_exp_f32 v208, v208 clamp
    v_exp_f32 v209, v209 clamp
    v_max_f32 v37, s54, v37
    v_cvt_pk_bf16_f32 v110, v56, v57
    v_pk_add_f32 v[36:37], v[36:37], v[208:209]
    v_cvt_pk_bf16_f32 v102, v36, v37
    v_pk_fma_f32 v[38:39], v[206:207], v[76:77], v[38:39] neg_lo:[1,0,0] neg_hi:[1,0,0]
    v_pk_fma_f32 v[58:59], v[206:207], v[80:81], v[58:59] neg_lo:[1,0,0] neg_hi:[1,0,0]
    v_pk_fma_f32 v[38:39], v[38:39], v[190:191], s[54:55]
    v_pk_mul_f32 v[58:59], v[58:59], v[190:191]
    v_pk_mul_f32 v[208:209], v[38:39], s[56:57]
    v_max_f32 v38, s54, v38
    v_exp_f32 v208, v208 clamp
    v_exp_f32 v209, v209 clamp
    v_max_f32 v39, s54, v39
    v_cvt_pk_bf16_f32 v111, v58, v59
    v_pk_add_f32 v[38:39], v[38:39], v[208:209]
    v_cvt_pk_bf16_f32 v103, v38, v39
    s_getpc_b64 s[48:49]
L_pc3:
    s_lshl2_add_u32 s47, s45, s3
    s_lshl_b32 s47, s47, 8
    v_add_u32 v232, s47, v17
    v_min_u32 v232, L_last-L_pc3, v232
    global_load_dword v15, v232, s[48:49]
    s_waitcnt vmcnt(7)
    s_barrier
    ds_read_b64_tr_b16 v[160:161], v8 offset:32768
    ds_read_b64_tr_b16 v[162:163], v8 offset:33280
    ds_read_b64_tr_b16 v[164:165], v8 offset:40960
    ds_read_b64_tr_b16 v[166:167], v8 offset:41472
    ds_read_b64_tr_b16 v[168:169], v8 offset:33792
    ds_read_b64_tr_b16 v[170:171], v8 offset:34304
    v_mfma_f32_16x16x32_bf16 v[112:115], v[104:107], v[96:99], 0
    v_mfma_f32_16x16x32_bf16 v[116:119], v[20:23], v[96:99], 0
    v_mfma_f32_16x16x32_bf16 v[112:115], v[108:111], v[100:103], v[112:115]
    v_mfma_f32_16x16x32_bf16 v[116:119], v[20:23], v[100:103], v[116:119]
    s_waitcnt lgkmcnt(4)
    v_mfma_f32_16x16x32_bf16 v[84:87], v[160:163], v[20:23], 0
    ds_read_b64_tr_b16 v[172:173], v8 offset:41984
    ds_read_b64_tr_b16 v[174:175], v8 offset:42496
    s_waitcnt lgkmcnt(4)
    v_mfma_f32_16x16x32_bf16 v[84:87], v[164:167], v[20:23], v[84:87]
    ds_read_b64_tr_b16 v[176:177], v8 offset:49152
    ds_read_b64_tr_b16 v[178:179], v8 offset:49664
    v_mfma_f32_16x16x32_bf16 v[60:63], v[160:163], a[0:3], 0
    v_mfma_f32_16x16x32_bf16 v[60:63], v[164:167], a[16:19], v[60:63]
    buffer_atomic_add_f32 v116, v149, s[36:39], 0 offen
    ds_read_b64_tr_b16 v[180:181], v8 offset:57344
    v_mfma_f32_16x16x32_bf16 v[64:67], v[160:163], a[4:7], 0
    ds_read_b64_tr_b16 v[182:183], v8 offset:57856
    v_mfma_f32_16x16x32_bf16 v[64:67], v[164:167], a[20:23], v[64:67]
    s_waitcnt lgkmcnt(6)
    v_mfma_f32_16x16x32_bf16 v[84:87], v[168:171], v[20:23], v[84:87]
    buffer_atomic_add_f32 v112, v148, s[36:39], 0 offen offset:0
    ds_read2_b32 v[224:225], v138 offset0:0 offset1:64
    s_waitcnt lgkmcnt(5)
    v_mfma_f32_16x16x32_bf16 v[84:87], v[172:175], v[20:23], v[84:87]
    ds_read2_b32 v[226:227], v138 offset0:16 offset1:80
    ds_read2_b32 v[228:229], v138 offset0:32 offset1:96
    v_mfma_f32_16x16x32_bf16 v[60:63], v[168:171], a[32:35], v[60:63]
    ds_read2_b32 v[230:231], v138 offset0:48 offset1:112
    ds_read_b32 v42, v139
    v_mfma_f32_16x16x32_bf16 v[60:63], v[172:175], a[48:51], v[60:63]
    buffer_atomic_add_f32 v113, v148, s[36:39], 0 offen offset:128
    ds_read_b64_tr_b16 v[184:185], v8 offset:50176
    v_mfma_f32_16x16x32_bf16 v[64:67], v[168:171], a[36:39], v[64:67]
    s_lshr_b32 s52, s2, 4
    ds_read_b64_tr_b16 v[186:187], v8 offset:50688
    v_mfma_f32_16x16x32_bf16 v[64:67], v[172:175], a[52:55], v[64:67]
    s_lshl_b32 s52, s52, 8
    s_lshl1_add_u32 s52, s67, s52
    s_waitcnt lgkmcnt(9)
    v_mfma_f32_16x16x32_bf16 v[84:87], v[176:179], v[20:23], v[84:87]
    s_add_u32 s52, s52, 4915200
    buffer_atomic_add_f32 v114, v148, s[36:39], 0 offen offset:256
    s_waitcnt lgkmcnt(7)
    v_mfma_f32_16x16x32_bf16 v[84:87], v[180:183], v[20:23], v[84:87]
    ds_read_b64_tr_b16 v[188:189], v8 offset:58368
    ds_read_b64_tr_b16 v[190:191], v8 offset:58880
    v_mfma_f32_16x16x32_bf16 v[60:63], v[176:179], a[64:67], v[60:63]
    s_lshr_b32 s51, s7, 1
    s_lshl2_add_u32 s51, s4, s51
    v_mfma_f32_16x16x32_bf16 v[60:63], v[180:183], a[80:83], v[60:63]
    s_lshl_b32 s51, s51, 8
    buffer_atomic_add_f32 v115, v148, s[36:39], 0 offen offset:384
    v_mfma_f32_16x16x32_bf16 v[64:67], v[176:179], a[68:71], v[64:67]
    s_add_u32 s51, s51, 4997152
    ds_read_b64_tr_b16 v[192:193], v9 offset:0
    v_mfma_f32_16x16x32_bf16 v[64:67], v[180:183], a[84:87], v[64:67]
    ds_read_b64_tr_b16 v[194:195], v9 offset:512
    v_lshlrev_b32 v24, 16, v128
    s_waitcnt lgkmcnt(4)
    v_mfma_f32_16x16x32_bf16 v[84:87], v[184:187], v[20:23], v[84:87]
    v_and_b32 v25, 0xffff0000, v128
    v_sub_f32 v24, v24, v42
    s_waitcnt lgkmcnt(2)
    v_mfma_f32_16x16x32_bf16 v[84:87], v[188:191], v[20:23], v[84:87]
    ds_read_b64_tr_b16 v[196:197], v9 offset:8192
    v_sub_f32 v25, v25, v42
    v_mfma_f32_16x16x32_bf16 v[60:63], v[184:187], a[96:99], v[60:63]
    ds_read_b64_tr_b16 v[198:199], v9 offset:8704
    v_lshlrev_b32 v26, 16, v129
    v_mfma_f32_16x16x32_bf16 v[60:63], v[188:191], a[112:115], v[60:63]
    v_and_b32 v27, 0xffff0000, v129
    v_sub_f32 v26, v26, v42
    v_mfma_f32_16x16x32_bf16 v[64:67], v[184:187], a[100:103], v[64:67]
    ds_read_b64_tr_b16 v[200:201], v9 offset:1024
    v_sub_f32 v27, v27, v42
    v_mfma_f32_16x16x32_bf16 v[64:67], v[188:191], a[116:119], v[64:67]
    ds_read_b64_tr_b16 v[202:203], v9 offset:1536
    v_lshlrev_b32 v28, 16, v130
    s_waitcnt lgkmcnt(4)
    v_mfma_f32_16x16x32_bf16 v[84:87], v[192:195], v[20:23], v[84:87]
L_pad2:
    s_cbranch_execz L_padret1
    v_and_b32 v29, 0xffff0000, v130
    v_sub_f32 v28, v28, v42
    s_waitcnt lgkmcnt(2)
    v_mfma_f32_16x16x32_bf16 v[84:87], v[196:199], v[20:23], v[84:87]
    ds_read_b64_tr_b16 v[204:205], v9 offset:9216
    v_sub_f32 v29, v29, v42
    v_mfma_f32_16x16x32_bf16 v[60:63], v[192:195], a[128:131], v[60:63]
    ds_read_b64_tr_b16 v[206:207], v9 offset:9728
    v_lshlrev_b32 v30, 16, v131
    v_mfma_f32_16x16x32_bf16 v[60:63], v[196:199], a[144:147], v[60:63]
    v_and_b32 v31, 0xffff0000, v131
    v_sub_f32 v30, v30, v42
    v_mfma_f32_16x16x32_bf16 v[64:67], v[192:195], a[132:135], v[64:67]
    ds_read_b64_tr_b16 v[208:209], v9 offset:16384
    v_sub_f32 v31, v31, v42
    v_mfma_f32_16x16x32_bf16 v[64:67], v[196:199], a[148:151], v[64:67]
    ds_read_b64_tr_b16 v[210:211], v9 offset:16896
    v_lshlrev_b32 v32, 16, v132
    v_and_b32 v33, 0xffff0000, v132
    v_sub_f32 v32, v32, v42
    v_sub_f32 v33, v33, v42
    ds_read_b64_tr_b16 v[212:213], v9 offset:24576
    ds_read_b64_tr_b16 v[214:215], v9 offset:25088
    s_waitcnt vmcnt(6)
    s_cmp_eq_u32 s7, 3
    s_cbranch_scc1 L_rare4
L_back4:
    s_waitcnt lgkmcnt(6)
    v_mfma_f32_16x16x32_bf16 v[84:87], v[200:203], v[20:23], v[84:87]
    ds_read_b64_tr_b16 v[44:45], v150 offset:0
    ds_read_b64_tr_b16 v[46:47], v150 offset:1024
    ds_read_b64_tr_b16 v[48:49], v150 offset:32
    s_waitcnt lgkmcnt(7)
    v_mfma_f32_16x16x32_bf16 v[84:87], v[204:207], v[20:23], v[84:87]
    ds_read_b64_tr_b16 v[50:51], v150 offset:1056
    ds_read_b64_tr_b16 v[52:53], v150 offset:64
    ds_read_b64_tr_b16 v[54:55], v150 offset:1088
    v_mfma_f32_16x16x32_bf16 v[60:63], v[200:203], a[160:163], v[60:63]
    ds_read_b64_tr_b16 v[56:57], v150 offset:96
    ds_read_b64_tr_b16 v[58:59], v150 offset:1120
    ds_read_b64_tr_b16 v[104:105], v151 offset:4096
    v_mfma_f32_16x16x32_bf16 v[60:63], v[204:207], a[176:179], v[60:63]
    ds_read_b64_tr_b16 v[106:107], v151 offset:4608
    ds_read_b64_tr_b16 v[108:109], v151 offset:4160
    ds_read_b64_tr_b16 v[110:111], v151 offset:4672
    v_mfma_f32_16x16x32_bf16 v[64:67], v[200:203], a[164:167], v[64:67]
    v_lshlrev_b32 v34, 16, v133
    v_and_b32 v35, 0xffff0000, v133
    v_sub_f32 v34, v34, v42
    v_mfma_f32_16x16x32_bf16 v[64:67], v[204:207], a[180:183], v[64:67]
    ds_read_b64_tr_b16 v[216:217], v9 offset:17408
    ds_read_b64_tr_b16 v[218:219], v9 offset:17920
    v_sub_f32 v35, v35, v42
    s_waitcnt lgkmcnt(15)
    v_mfma_f32_16x16x32_bf16 v[84:87], v[208:211], v[20:23], v[84:87]
    v_lshlrev_b32 v36, 16, v134
    v_and_b32 v37, 0xffff0000, v134
    v_sub_f32 v36, v36, v42
    s_waitcnt lgkmcnt(14)
    v_mfma_f32_16x16x32_bf16 v[84:87], v[212:215], v[20:23], v[84:87]
    ds_read_b64_tr_b16 v[220:221], v9 offset:25600
    ds_read_b64_tr_b16 v[222:223], v9 offset:26112
    v_sub_f32 v37, v37, v42
    v_mfma_f32_16x16x32_bf16 v[60:63], v[208:211], a[192:195], v[60:63]
    s_waitcnt lgkmcnt(14)
    buffer_store_dwordx4 v[44:47], v152, s[36:39], 0 offen sc1
    v_lshlrev_b32 v38, 16, v135
    v_and_b32 v39, 0xffff0000, v135
    v_mfma_f32_16x16x32_bf16 v[60:63], v[212:215], a[208:211], v[60:63]
    v_sub_f32 v38, v38, v42
    v_sub_f32 v39, v39, v42
    v_mfma_f32_16x16x32_bf16 v[64:67], v[208:211], a[196:199], v[64:67]
    v_mfma_f32_16x16x32_bf16 v[64:67], v[212:215], a[212:215], v[64:67]
    s_waitcnt lgkmcnt(2)
    v_mfma_f32_16x16x32_bf16 v[84:87], v[216:219], v[20:23], v[84:87]
    s_waitcnt lgkmcnt(0)
    v_mfma_f32_16x16x32_bf16 v[84:87], v[220:223], v[20:23], v[84:87]
    buffer_store_dwordx4 v[48:51], v152, s[36:39], s75 offen sc1
    v_mfma_f32_16x16x32_bf16 v[60:63], v[216:219], a[224:227], v[60:63]
    v_mfma_f32_16x16x32_bf16 v[60:63], v[220:223], a[240:243], v[60:63]
    v_mfma_f32_16x16x32_bf16 v[64:67], v[216:219], a[228:231], v[64:67]
    v_mfma_f32_16x16x32_bf16 v[64:67], v[220:223], a[244:247], v[64:67]
    s_barrier
    v_mfma_f32_16x16x32_bf16 v[68:71], v[160:163], a[8:11], 0
    s_mov_b32 s49, 65536
    buffer_store_dwordx4 v[52:55], v152, s[36:39], s49 offen sc1
    v_mfma_f32_16x16x32_bf16 v[68:71], v[164:167], a[24:27], v[68:71]
    v_mfma_f32_16x16x32_bf16 v[68:71], v[168:171], a[40:43], v[68:71]
    v_mfma_f32_16x16x32_bf16 v[68:71], v[172:175], a[56:59], v[68:71]
    s_mov_b32 s49, 98304
    buffer_store_dwordx4 v[56:59], v152, s[36:39], s49 offen sc1
    v_mfma_f32_16x16x32_bf16 v[68:71], v[176:179], a[72:75], v[68:71]
    v_fma_f32 v60, -v84, v225, v60
    v_fma_f32 v61, -v85, v225, v61
    v_mfma_f32_16x16x32_bf16 v[68:71], v[180:183], a[88:91], v[68:71]
    v_fma_f32 v60, v60, v224, s54
    v_fma_f32 v61, v61, v224, s54
    v_mfma_f32_16x16x32_bf16 v[68:71], v[184:187], a[104:107], v[68:71]
    v_mul_f32 v120, s56, v60
    v_mul_f32 v121, s56, v61
    v_mfma_f32_16x16x32_bf16 v[68:71], v[188:191], a[120:123], v[68:71]
    buffer_store_dwordx4 v[104:107], v153, s[36:39], 0 offen sc1
    v_mfma_f32_16x16x32_bf16 v[68:71], v[192:195], a[136:139], v[68:71]
    v_exp_f32 v120, v120 clamp
    v_mfma_f32_16x16x32_bf16 v[68:71], v[196:199], a[152:155], v[68:71]
    v_exp_f32 v121, v121 clamp
    v_mfma_f32_16x16x32_bf16 v[68:71], v[200:203], a[168:171], v[68:71]
    v_max_f32 v60, s54, v60
    v_max_f32 v61, s54, v61
    v_mfma_f32_16x16x32_bf16 v[68:71], v[204:207], a[184:187], v[68:71]
    s_mov_b32 s49, 114688
    buffer_store_dwordx4 v[108:111], v153, s[36:39], s49 offen sc1
    v_mfma_f32_16x16x32_bf16 v[68:71], v[208:211], a[200:203], v[68:71]
    v_add_f32 v60, v60, v120
    v_add_f32 v61, v61, v121
    v_mfma_f32_16x16x32_bf16 v[68:71], v[212:215], a[216:219], v[68:71]
    v_cvt_pk_bf16_f32 v96, v60, v61
    v_fma_f32 v62, -v86, v225, v62
    v_mfma_f32_16x16x32_bf16 v[68:71], v[216:219], a[232:235], v[68:71]
    v_fma_f32 v63, -v87, v225, v63
    v_fma_f32 v62, v62, v224, s54
    v_mfma_f32_16x16x32_bf16 v[68:71], v[220:223], a[248:251], v[68:71]
    s_add_u32 m0, s0, 0
    s_xor_b32 s1, s73, 0
    v_mfma_f32_16x16x32_bf16 v[72:75], v[160:163], a[12:15], 0
    buffer_load_dwordx4 v156, s[16:19], s1 offen offset:0 lds
    v_fma_f32 v63, v63, v224, s54
    v_mfma_f32_16x16x32_bf16 v[72:75], v[164:167], a[28:31], v[72:75]
    v_mul_f32 v120, s56, v62
    v_mul_f32 v121, s56, v63
    v_mfma_f32_16x16x32_bf16 v[72:75], v[168:171], a[44:47], v[72:75]
    buffer_load_dwordx4 v157, s[16:19], s1 offen offset:1024 lds
    v_mfma_f32_16x16x32_bf16 v[72:75], v[172:175], a[60:63], v[72:75]
    v_exp_f32 v120, v120 clamp
    v_mfma_f32_16x16x32_bf16 v[72:75], v[176:179], a[76:79], v[72:75]
    v_exp_f32 v121, v121 clamp
    v_mfma_f32_16x16x32_bf16 v[72:75], v[180:183], a[92:95], v[72:75]
    v_max_f32 v62, s54, v62
    v_max_f32 v63, s54, v63
    v_mfma_f32_16x16x32_bf16 v[72:75], v[184:187], a[108:111], v[72:75]
    buffer_load_dwordx4 v158, s[16:19], s1 offen offset:2048 lds
    v_add_f32 v62, v62, v120
    v_mfma_f32_16x16x32_bf16 v[72:75], v[188:191], a[124:127], v[72:75]
    v_add_f32 v63, v63, v121
    v_cvt_pk_bf16_f32 v97, v62, v63
    v_mfma_f32_16x16x32_bf16 v[72:75], v[192:195], a[140:143], v[72:75]
    v_fma_f32 v64, -v84, v227, v64
    v_fma_f32 v65, -v85, v227, v65
    v_mfma_f32_16x16x32_bf16 v[72:75], v[196:199], a[156:159], v[72:75]
    v_fma_f32 v64, v64, v226, s54
    v_fma_f32 v65, v65, v226, s54
    v_mfma_f32_16x16x32_bf16 v[72:75], v[200:203], a[172:175], v[72:75]
    buffer_load_dwordx4 v159, s[16:19], s1 offen offset:3072 lds
    v_mul_f32 v120, s56, v64
    v_mfma_f32_16x16x32_bf16 v[72:75], v[204:207], a[188:191], v[72:75]
    v_mul_f32 v121, s56, v65
    v_mfma_f32_16x16x32_bf16 v[72:75], v[208:211], a[204:207], v[72:75]
    v_exp_f32 v120, v120 clamp
    v_mfma_f32_16x16x32_bf16 v[72:75], v[212:215], a[220:223], v[72:75]
    v_exp_f32 v121, v121 clamp
    v_mfma_f32_16x16x32_bf16 v[72:75], v[216:219], a[236:239], v[72:75]
    v_max_f32 v64, s54, v64
    v_max_f32 v65, s54, v65
    v_mfma_f32_16x16x32_bf16 v[72:75], v[220:223], a[252:255], v[72:75]
    v_add_f32 v64, v64, v120
    v_add_f32 v65, v65, v121
    v_cvt_pk_bf16_f32 v98, v64, v65
    v_fma_f32 v66, -v86, v227, v66
    v_fma_f32 v67, -v87, v227, v67
    v_fma_f32 v66, v66, v226, s54
    v_fma_f32 v67, v67, v226, s54
    v_mul_f32 v120, s56, v66
    v_mul_f32 v121, s56, v67
    v_exp_f32 v120, v120 clamp
    v_exp_f32 v121, v121 clamp
    v_max_f32 v66, s54, v66
    v_max_f32 v67, s54, v67
    v_add_f32 v66, v66, v120
    v_add_f32 v67, v67, v121
    v_cvt_pk_bf16_f32 v99, v66, v67
    v_permlane16_swap_b32 v96, v98
    s_nop 0
    v_permlane16_swap_b32 v97, v99
    buffer_store_dwordx4 v[96:99], v154, s[36:39], 0 offen sc1
    s_waitcnt vmcnt(11)
    s_cmp_eq_u32 s7, 3
    s_cbranch_scc1 L_rare5
L_back5:
    s_barrier
    s_atomic_add s76, s[36:37], s52 offset:0x0
    s_atomic_add s76, s[36:37], s52 offset:0x1000
    v_pk_fma_f32 v[68:69], v[84:85], v[228:229], v[68:69] op_sel:[0,1,0] op_sel_hi:[1,1,1] neg_lo:[1,0,0] neg_hi:[1,0,0]
    v_pk_fma_f32 v[68:69], v[68:69], v[228:229], s[54:55] op_sel_hi:[1,0,1]
    v_pk_mul_f32 v[120:121], v[68:69], s[56:57]
    v_exp_f32 v120, v120 clamp
    v_exp_f32 v121, v121 clamp
    v_max_f32 v68, s54, v68
    v_max_f32 v69, s54, v69
    v_pk_add_f32 v[68:69], v[68:69], v[120:121]
    v_cvt_pk_bf16_f32 v100, v68, v69
    v_pk_fma_f32 v[70:71], v[86:87], v[228:229], v[70:71] op_sel:[0,1,0] op_sel_hi:[1,1,1] neg_lo:[1,0,0] neg_hi:[1,0,0]
    v_pk_fma_f32 v[70:71], v[70:71], v[228:229], s[54:55] op_sel_hi:[1,0,1]
    v_pk_mul_f32 v[120:121], v[70:71], s[56:57]
    v_exp_f32 v120, v120 clamp
    v_exp_f32 v121, v121 clamp
    v_max_f32 v70, s54, v70
    v_max_f32 v71, s54, v71
    v_pk_add_f32 v[70:71], v[70:71], v[120:121]
    v_cvt_pk_bf16_f32 v101, v70, v71
    v_pk_fma_f32 v[72:73], v[84:85], v[230:231], v[72:73] op_sel:[0,1,0] op_sel_hi:[1,1,1] neg_lo:[1,0,0] neg_hi:[1,0,0]
    v_pk_fma_f32 v[72:73], v[72:73], v[230:231], s[54:55] op_sel_hi:[1,0,1]
    v_pk_mul_f32 v[120:121], v[72:73], s[56:57]
    v_exp_f32 v120, v120 clamp
    v_exp_f32 v121, v121 clamp
    v_max_f32 v72, s54, v72
    v_max_f32 v73, s54, v73
    v_pk_add_f32 v[72:73], v[72:73], v[120:121]
    v_cvt_pk_bf16_f32 v102, v72, v73
    v_pk_fma_f32 v[74:75], v[86:87], v[230:231], v[74:75] op_sel:[0,1,0] op_sel_hi:[1,1,1] neg_lo:[1,0,0] neg_hi:[1,0,0]
    v_pk_fma_f32 v[74:75], v[74:75], v[230:231], s[54:55] op_sel_hi:[1,0,1]
    v_pk_mul_f32 v[120:121], v[74:75], s[56:57]
    v_exp_f32 v120, v120 clamp
    v_exp_f32 v121, v121 clamp
    v_max_f32 v74, s54, v74
    v_max_f32 v75, s54, v75
    v_pk_add_f32 v[74:75], v[74:75], v[120:121]
    v_cvt_pk_bf16_f32 v103, v74, v75
    v_permlane16_swap_b32 v100, v102
    s_nop 0
    v_permlane16_swap_b32 v101, v103
    buffer_store_dwordx4 v[100:103], v155, s[36:39], 0 offen sc1
    s_getpc_b64 s[48:49]
L_pc6:
    s_lshl2_add_u32 s47, s45, s3
    s_lshl_b32 s47, s47, 8
    v_add_u32 v160, s47, v17
    v_min_u32 v160, L_last-L_pc6, v160
    global_load_dword v15, v160, s[48:49]
    s_add_u32 m0, s0, 4096
    s_xor_b32 s1, s73, 16384
    buffer_load_dwordx4 v156, s[16:19], s1 offen offset:0 lds
    v_bfe_u32 v168, v0, 2, 2
    v_and_b32 v169, 3, v0
    v_bfe_u32 v170, v0, 4, 1
    v_xor_b32 v236, s3, v168
    v_lshlrev_b32 v236, 6, v236
    v_lshl_add_u32 v236, v168, 10, v236
    v_lshl_add_u32 v236, v40, 8, v236
    v_lshl_add_u32 v236, v170, 5, v236
    v_lshl_add_u32 v236, v169, 3, v236
    v_add_u32 v237, 98304, v236
    s_lshr_b32 s49, s74, 3
    s_xor_b32 s49, s49, s3
    s_lshl_b32 s47, s49, 13
    s_add_u32 s48, s47, 4718592
    v_bfe_u32 v238, v0, 2, 3
    buffer_load_dwordx4 v157, s[16:19], s1 offen offset:1024 lds
    v_lshl_add_u32 v238, v238, 7, s48
    v_lshl_add_u32 v238, v169, 4, v238
    v_lshl_add_u32 v238, v40, 6, v238
    s_mul_i32 s48, s64, 33792
    s_add_u32 s48, s48, s47
    v_add_u32 v239, s48, v16
    s_lshl_b32 s47, s3, 13
    v_add_u32 v244, 65536, v16
    v_add_u32 v243, s47, v244
    s_add_u32 s77, s47, 65536
    s_lshr_b32 s56, s64, 1
    s_lshl2_add_u32 s56, s56, s49
    s_lshl_b32 s56, s56, 8
    s_add_u32 s56, s56, 4997152
    s_lshl_b32 s47, s49, 10
    buffer_load_dwordx4 v158, s[16:19], s1 offen offset:2048 lds
    s_add_u32 s47, s47, 4751360
    s_and_b32 s74, s74, 7
    s_lshl_b32 s48, s74, 7
    v_xor_b32 v240, s48, v16
    v_add_u32 v240, s47, v240
    s_lshl_b32 s74, s74, 10
    v_lshl_add_u32 v242, v40, 4, s77
    v_lshl_add_u32 v241, v40, 4, v242
    v_lshl_add_u32 v241, v170, 4, v241
    v_xor_b32 v249, v0, v170
    v_and_b32 v249, 1, v249
    v_lshl_add_u32 v242, v249, 5, v242
    v_lshlrev_b32 v246, 8, v19
    v_lshl_add_u32 v246, v14, 2, v246
    v_add_u32 v246, 49152, v246
    buffer_load_dwordx4 v159, s[16:19], s1 offen offset:3072 lds
    s_lshl_b32 s47, s3, 6
    v_add_u32 v245, s47, v246
    s_lshl2_add_u32 s47, s5, s3
    s_lshl4_add_u32 s48, s64, s47
    s_mul_i32 s49, s64, 33792
    s_lshl_b32 s50, s47, 11
    s_add_u32 s49, s49, s50
    s_add_u32 s49, s49, 2359296
    v_add_u32 v247, s49, v16
    v_lshl_add_u32 v250, v40, 28, v17
    s_lshl_b32 s49, s48, 7
    s_add_u32 s49, s49, 4784128
    v_lshl_add_u32 v248, v1, 4, s49
    v_and_b32 v249, 3, v18
    v_lshl_add_u32 v248, v249, 2, v248
    s_add_u32 m0, s0, 8192
    s_xor_b32 s1, s73, 32768
    buffer_load_dwordx4 v156, s[16:19], s1 offen offset:0 lds
    v_lshl_add_u32 v248, v40, 28, v248
    s_lshl_b32 s47, s47, 26
    s_lshl_b32 s49, s64, 7
    s_add_u32 s49, s49, s47
    s_add_u32 s49, s49, 4759552
    v_add_u32 v250, s49, v250
    s_sub_u32 s49, s49, 128
    v_add_u32 v250, s49, v17
    v_cmp_gt_u32 vcc, 32, v0
    s_nop 1
    v_cndmask_b32 v248, v250, v248, vcc
    s_lshl_b32 s64, s64, 8
    s_add_u32 s64, s64, 4980736
    s_lshl_b32 s47, s46, 12
    s_add_u32 s47, s47, 4915200
    v_lshl_add_u32 v252, v14, 8, s47
    buffer_load_dwordx4 v157, s[16:19], s1 offen offset:1024 lds
    v_lshl_add_u32 v252, v19, 28, v252
    v_mov_b32 v2, v156
    v_mov_b32 v3, v157
    v_mov_b32 v4, v158
    v_mov_b32 v5, v159
    v_mov_b32 v216, 0
    v_mov_b32 v217, 0
    v_mov_b32 v218, 0
    v_mov_b32 v219, 0
    v_mov_b32 v220, 0
    v_mov_b32 v221, 0
    v_mov_b32 v222, 0
    v_mov_b32 v223, 0
    v_mov_b32 v224, s54
    v_mov_b32 v225, s54
    v_mov_b32 v226, s54
    v_mov_b32 v227, s54
    v_mov_b32 v228, s54
    v_mov_b32 v229, s54
    v_mov_b32 v230, s54
    v_mov_b32 v231, s54
    s_xor_b32 s47, s74, 1024
    s_xor_b32 s48, s74, 2048
    s_xor_b32 s49, s74, 3072
    s_xor_b32 s50, s74, 4096
    s_xor_b32 s68, s74, 5120
    s_xor_b32 s69, s74, 6144
    s_xor_b32 s70, s74, 7168
    s_nop 0
    s_mov_b64 exec, 0
    s_cmp_eq_u32 s3, 0
    s_cbranch_scc1 L_pad3
    s_cmp_eq_u32 s3, 1
    s_cbranch_scc1 L_pad4
    s_cmp_eq_u32 s3, 2
    s_cbranch_scc1 L_pad5
    s_branch L_pad6
L_padret7:
    s_mov_b64 exec, -1
    s_waitcnt vmcnt(7)
    s_atomic_add s76, s[36:37], s51
    s_barrier
    s_atomic_add s76, s[36:37], s52 offset:0x8000
    s_atomic_add s76, s[36:37], s52 offset:0x9000
    buffer_load_dwordx4 v4, s[16:19], s1 offen offset:2048 lds
    s_lshr_b32 s55, s46, 2
    s_lshr_b32 s51, s45, 2
    s_lshl3_add_u32 s55, s55, s51
    s_lshl2_add_u32 s58, s55, s3
    s_and_b32 s55, s46, 3
    s_lshl2_add_u32 s59, s55, s5
    s_lshr_b32 s55, s45, 3
    s_lshl2_add_u32 s60, s46, s55
    s_and_b32 s61, s45, 7
    s_lshl_b32 s42, s58, 8
    s_add_u32 s42, s42, 4980736
    s_mul_i32 s25, s58, 33792
    s_add_u32 s25, s25, 2359296
    s_lshl_b32 s26, s46, 12
    s_lshl_b32 s27, s58, 11
    s_add_u32 s27, s27, 4784128
    s_mul_i32 s28, s58, 116
    s_mul_i32 s55, s59, 7
    s_add_u32 s28, s28, s55
    s_lshl_b32 s28, s28, 10
    buffer_load_dwordx4 v5, s[16:19], s1 offen offset:3072 lds
    s_add_u32 s28, s28, 7012352
    s_lshr_b32 s29, s58, 1
    s_lshr_b32 s55, s59, 2
    s_lshl2_add_u32 s29, s29, s55
    s_lshl_b32 s29, s29, 8
    s_add_u32 s29, s29, 4997120
    s_lshl2_add_u32 s30, s60, s3
    s_lshl_b32 s30, s30, 8
    s_add_u32 s30, s30, 4997120
    s_lshr_b32 s55, s3, 1
    s_lshl1_add_u32 s55, s60, s55
    s_and_b32 s51, s3, 1
    s_lshl1_add_u32 s51, s61, s51
    s_mul_i32 s31, s55, 33792
    s_xor_b32 s66, s51, 1
    s_lshl_b32 s66, s66, 11
    s_add_u32 s31, s31, s66
    s_add_u32 s31, s31, 2359296
    s_lshl_b32 s40, s55, 7
    s_lshl1_add_u32 s54, s40, 4980736
    s_add_u32 m0, s0, 12288
    s_xor_b32 s1, s73, 49152
    buffer_load_dwordx4 v2, s[16:19], s1 offen offset:0 lds
    s_add_u32 s40, s40, 4759552
    s_lshl2_add_u32 s41, s60, s3
    s_lshl_b32 s41, s41, 14
    s_lshl_b32 s66, s61, 7
    s_add_u32 s41, s41, s66
    s_mul_i32 s66, s3, 28672
    s_and_b32 s71, s46, 3
    s_mul_i32 s62, s55, 118784
    s_add_u32 s62, s62, s66
    s_add_u32 s62, s62, 7005184
    s_mul_i32 s63, s51, 114688
    s_add_u32 s63, s63, s66
    s_add_u32 s63, s63, 5104640
    s_xor_b32 s24, s71, 0
    s_mul_i32 s24, s24, 7168
    s_add_u32 s8, s62, s24
    s_add_u32 s4, s63, s24
    s_xor_b32 s24, s71, 1
    s_mul_i32 s24, s24, 7168
    s_add_u32 s9, s62, s24
    buffer_load_dwordx4 v3, s[16:19], s1 offen offset:1024 lds
    s_add_u32 s6, s63, s24
    s_xor_b32 s24, s71, 2
    s_mul_i32 s24, s24, 7168
    s_add_u32 s10, s62, s24
    s_add_u32 s7, s63, s24
    s_xor_b32 s24, s71, 3
    s_mul_i32 s24, s24, 7168
    s_add_u32 s11, s62, s24
    s_add_u32 s44, s63, s24
    s_xor_b32 s55, s55, 1
    s_xor_b32 s51, s51, 1
    s_mul_i32 s62, s55, 118784
    s_add_u32 s62, s62, s66
    s_add_u32 s62, s62, 7005184
    s_mul_i32 s63, s51, 114688
    s_add_u32 s63, s63, s66
    s_add_u32 s63, s63, 5104640
    s_xor_b32 s24, s71, 0
    s_mul_i32 s24, s24, 7168
    s_add_u32 s12, s62, s24
    buffer_load_dwordx4 v4, s[16:19], s1 offen offset:2048 lds
    s_add_u32 s20, s63, s24
    s_xor_b32 s24, s71, 1
    s_mul_i32 s24, s24, 7168
    s_add_u32 s13, s62, s24
    s_add_u32 s21, s63, s24
    s_xor_b32 s24, s71, 2
    s_mul_i32 s24, s24, 7168
    s_add_u32 s14, s62, s24
    s_add_u32 s22, s63, s24
    s_xor_b32 s24, s71, 3
    s_mul_i32 s24, s24, 7168
    s_add_u32 s15, s62, s24
    s_add_u32 s23, s63, s24
    s_xor_b32 s55, s55, 1
    s_xor_b32 s51, s51, 1
    v_lshlrev_b32 v6, 9, v19
    v_lshl_add_u32 v6, v14, 4, v6
    v_add_u32 v7, 7168, v6
    v_add_u32 v1, 4096, v7
    s_and_b32 s71, s71, 1
    buffer_load_dwordx4 v5, s[16:19], s1 offen offset:3072 lds
    s_mul_i32 s71, s71, 7168
    s_sub_u32 s71, 11264, s71
    v_mul_u32_u24 v12, 6144, v40
    v_add3_u32 v12, v12, v6, s71
    s_mul_i32 s51, s59, 229376
    s_add_u32 s51, s51, 14942208
    s_add_u32 s55, s67, s26
    s_and_b32 s55, s55, 0x7fff
    s_add_u32 s43, s51, s55
    s_xor_b32 s55, s55, 0x4000
    s_add_u32 s53, s51, s55
    v_mov_b32 v10, v40
    v_mov_b32 v13, v43
    v_add_u32 v11, 4096, v16
    v_add_u32 v8, 0x10000, v6
    v_add_u32 v9, 0x10000, v8
    s_cmp_eq_u32 s3, 0
    s_cselect_b32 s55, 0xffff, 0
    s_lshl_b32 s51, s3, 26
    v_add_u32 v251, s51, v252
    buffer_load_dword v23, v251, s[36:39], 0 offen sc1
    s_mov_b32 s57, 0
    s_atomic_add s57, s[36:37], s56 offset:0x0 glc
    s_add_u32 m0, s0, 98304
    s_xor_b32 s1, s73, 262144
    buffer_load_dwordx4 v2, s[16:19], s1 offen offset:0 lds
    buffer_load_dwordx4 v3, s[16:19], s1 offen offset:1024 lds
    buffer_load_dwordx4 v4, s[16:19], s1 offen offset:2048 lds
    buffer_load_dwordx4 v5, s[16:19], s1 offen offset:3072 lds
    s_add_u32 m0, s0, 102400
    s_xor_b32 s1, s73, 278528
    buffer_load_dwordx4 v2, s[16:19], s1 offen offset:0 lds
    buffer_load_dwordx4 v3, s[16:19], s1 offen offset:1024 lds
    buffer_load_dwordx4 v4, s[16:19], s1 offen offset:2048 lds
    buffer_load_dwordx4 v5, s[16:19], s1 offen offset:3072 lds
    s_mov_b32 m0, s77
    s_waitcnt vmcnt(8)
    v_cmp_gt_u32 vcc, 16, v23
    s_nop 0
    s_and_b32 vcc_lo, vcc_lo, s55
    s_cbranch_scc1 L_rare8
L_back8:
    s_waitcnt lgkmcnt(0)
    s_cmp_lt_u32 s57, 8
    s_cbranch_scc1 L_rare9
L_back9:
    s_barrier
    buffer_load_dwordx4 v240, s[36:39], 0 offen sc1 lds
    ds_read_b64_tr_b16 a[0:1], v236 offset:0
    ds_read_b64_tr_b16 a[2:3], v236 offset:512
    ds_read_b64_tr_b16 a[16:17], v236 offset:16384
    ds_read_b64_tr_b16 a[18:19], v236 offset:16896
    buffer_load_dwordx4 v[48:51], v238, s[36:39], s74 offen sc1
    ds_read_b64_tr_b16 a[32:33], v236 offset:32768
    ds_read_b64_tr_b16 a[34:35], v236 offset:33280
    ds_read_b64_tr_b16 a[48:49], v236 offset:49152
    ds_read_b64_tr_b16 a[50:51], v236 offset:49664
    buffer_load_dwordx4 v[80:83], v239, s[36:39], s74 offen sc1
    ds_read_b64_tr_b16 a[4:5], v236 offset:4096
    ds_read_b64_tr_b16 a[6:7], v236 offset:4608
    ds_read_b64_tr_b16 a[20:21], v236 offset:20480
    ds_read_b64_tr_b16 a[22:23], v236 offset:20992
    buffer_load_dwordx4 v[52:55], v238, s[36:39], s47 offen sc1
    ds_read_b64_tr_b16 a[36:37], v236 offset:36864
    ds_read_b64_tr_b16 a[38:39], v236 offset:37376
    ds_read_b64_tr_b16 a[52:53], v236 offset:53248
    ds_read_b64_tr_b16 a[54:55], v236 offset:53760
    buffer_load_dwordx4 v[84:87], v239, s[36:39], s47 offen sc1
    ds_read_b64_tr_b16 a[8:9], v236 offset:8192
    ds_read_b64_tr_b16 a[10:11], v236 offset:8704
    ds_read_b64_tr_b16 a[24:25], v236 offset:24576
    ds_read_b64_tr_b16 a[26:27], v236 offset:25088
    buffer_load_dwordx4 v[56:59], v238, s[36:39], s48 offen sc1
    ds_read_b64_tr_b16 a[40:41], v236 offset:40960
    ds_read_b64_tr_b16 a[42:43], v236 offset:41472
    ds_read_b64_tr_b16 a[56:57], v236 offset:57344
    ds_read_b64_tr_b16 a[58:59], v236 offset:57856
    buffer_load_dwordx4 v[88:91], v239, s[36:39], s48 offen sc1
    ds_read_b64_tr_b16 a[12:13], v236 offset:12288
    ds_read_b64_tr_b16 a[14:15], v236 offset:12800
    ds_read_b64_tr_b16 a[28:29], v236 offset:28672
    ds_read_b64_tr_b16 a[30:31], v236 offset:29184
    buffer_load_dwordx4 v[60:63], v238, s[36:39], s49 offen sc1
    ds_read_b64_tr_b16 a[44:45], v236 offset:45056
    ds_read_b64_tr_b16 a[46:47], v236 offset:45568
    ds_read_b64_tr_b16 a[60:61], v236 offset:61440
    ds_read_b64_tr_b16 a[62:63], v236 offset:61952
    buffer_load_dwordx4 v[92:95], v239, s[36:39], s49 offen sc1
    s_waitcnt vmcnt(8)
    ds_read_b128 v[192:195], v241 offset:0
    ds_read_b128 v[196:199], v241 offset:128
    ds_read_b128 v[200:203], v241 offset:256
    ds_read_b128 v[204:207], v241 offset:384
    ds_read_b128 v[208:211], v241 offset:512
    ds_read_b128 v[212:215], v241 offset:640
    ds_read_b128 v[112:115], v241 offset:768
    ds_read_b128 v[116:119], v241 offset:896
    buffer_load_dwordx4 v[64:67], v238, s[36:39], s50 offen sc1
    ds_read_b128 a[128:131], v242 offset:64
    ds_read_b128 a[132:135], v242 offset:192
    ds_read_b128 a[136:139], v242 offset:320
    ds_read_b128 a[140:143], v242 offset:448
    ds_read_b128 a[144:147], v242 offset:576
    ds_read_b128 a[148:151], v242 offset:704
    ds_read_b128 a[152:155], v242 offset:832
    ds_read_b128 a[156:159], v242 offset:960
    buffer_load_dwordx4 v[96:99], v239, s[36:39], s50 offen sc1
    s_waitcnt lgkmcnt(15)
    v_cvt_pk_bf16_f32 v195, v194, v195
    v_cvt_pk_bf16_f32 v194, v192, v193
    s_waitcnt vmcnt(9)
    v_cvt_pk_bf16_f32 v192, v48, v49
    v_cvt_pk_bf16_f32 v193, v50, v51
    s_waitcnt lgkmcnt(14)
    v_cvt_pk_bf16_f32 v199, v198, v199
    v_cvt_pk_bf16_f32 v198, v196, v197
    v_permlane16_swap_b32 v192, v194
    v_permlane16_swap_b32 v193, v195
    s_waitcnt vmcnt(7)
    v_cvt_pk_bf16_f32 v196, v52, v53
    v_cvt_pk_bf16_f32 v197, v54, v55
    v_mfma_f32_32x32x16_bf16 v[136:151], v[192:195], v[80:83], v[216:231]
    v_permlane16_swap_b32 v196, v198
    v_permlane16_swap_b32 v197, v199
    buffer_load_dwordx4 v[68:71], v238, s[36:39], s68 offen sc1
    s_waitcnt lgkmcnt(13)
    v_cvt_pk_bf16_f32 v203, v202, v203
    v_cvt_pk_bf16_f32 v202, v200, v201
    s_waitcnt lgkmcnt(12)
    v_cvt_pk_bf16_f32 v207, v206, v207
    v_cvt_pk_bf16_f32 v206, v204, v205
    s_waitcnt lgkmcnt(11)
    v_cvt_pk_bf16_f32 v211, v210, v211
    v_cvt_pk_bf16_f32 v210, v208, v209
    s_waitcnt lgkmcnt(10)
    v_cvt_pk_bf16_f32 v215, v214, v215
    v_cvt_pk_bf16_f32 v214, v212, v213
    s_waitcnt lgkmcnt(9)
    v_cvt_pk_bf16_f32 v115, v114, v115
    v_cvt_pk_bf16_f32 v114, v112, v113
    s_waitcnt lgkmcnt(8)
    v_cvt_pk_bf16_f32 v119, v118, v119
    v_cvt_pk_bf16_f32 v118, v116, v117
    v_rcp_f32 v144, v144
    s_nop 0
    v_pk_mul_f32 v[136:137], v[136:137], v[144:145] op_sel_hi:[1,0]
    v_pk_mul_f32 v[138:139], v[138:139], v[144:145] op_sel_hi:[1,0]
    v_pk_mul_f32 v[140:141], v[140:141], v[144:145] op_sel_hi:[1,0]
    v_pk_mul_f32 v[142:143], v[142:143], v[144:145] op_sel_hi:[1,0]
    s_waitcnt vmcnt(7)
    v_mfma_f32_32x32x16_bf16 v[152:167], v[196:199], v[84:87], v[216:231]
    buffer_load_dwordx4 v[100:103], v239, s[36:39], s68 offen sc1
    v_cvt_pk_bf16_f32 v168, v136, v137
    v_cvt_pk_bf16_f32 v169, v138, v139
    v_cvt_pk_bf16_f32 v170, v140, v141
    v_cvt_pk_bf16_f32 v171, v142, v143
    s_waitcnt vmcnt(7)
    v_cvt_pk_bf16_f32 v200, v56, v57
    v_cvt_pk_bf16_f32 v201, v58, v59
    s_waitcnt lgkmcnt(7)
    v_mfma_f32_16x16x32_bf16 v[176:179], a[128:131], v[168:171], 0
    ds_write_b128 v243, v[168:171] offset:0
    buffer_load_dwordx4 v[72:75], v238, s[36:39], s69 offen sc1
    v_permlane16_swap_b32 v200, v202
    v_rcp_f32 v160, v160
    v_permlane16_swap_b32 v201, v203
    v_pk_mul_f32 v[152:153], v[152:153], v[160:161] op_sel_hi:[1,0]
    v_pk_mul_f32 v[154:155], v[154:155], v[160:161] op_sel_hi:[1,0]
    v_pk_mul_f32 v[156:157], v[156:157], v[160:161] op_sel_hi:[1,0]
    v_pk_mul_f32 v[158:159], v[158:159], v[160:161] op_sel_hi:[1,0]
    s_waitcnt vmcnt(7)
    v_mfma_f32_32x32x16_bf16 v[136:151], v[200:203], v[88:91], v[216:231]
L_pad3:
    s_cbranch_execz L_padret7
    buffer_load_dwordx4 v[104:107], v239, s[36:39], s69 offen sc1
    v_cvt_pk_bf16_f32 v172, v152, v153
    v_cvt_pk_bf16_f32 v173, v154, v155
    v_cvt_pk_bf16_f32 v174, v156, v157
    v_cvt_pk_bf16_f32 v175, v158, v159
    s_waitcnt vmcnt(7)
    v_cvt_pk_bf16_f32 v204, v60, v61
    v_cvt_pk_bf16_f32 v205, v62, v63
    s_waitcnt lgkmcnt(7)
    v_mfma_f32_16x16x32_bf16 v[176:179], a[132:135], v[172:175], v[176:179]
    ds_write_b128 v243, v[172:175] offset:1024
    buffer_load_dwordx4 v[76:79], v238, s[36:39], s70 offen sc1
    v_permlane16_swap_b32 v204, v206
    v_rcp_f32 v144, v144
    v_permlane16_swap_b32 v205, v207
    v_pk_mul_f32 v[136:137], v[136:137], v[144:145] op_sel_hi:[1,0]
    v_pk_mul_f32 v[138:139], v[138:139], v[144:145] op_sel_hi:[1,0]
    v_pk_mul_f32 v[140:141], v[140:141], v[144:145] op_sel_hi:[1,0]
    v_pk_mul_f32 v[142:143], v[142:143], v[144:145] op_sel_hi:[1,0]
    s_waitcnt vmcnt(7)
    v_mfma_f32_32x32x16_bf16 v[152:167], v[204:207], v[92:95], v[216:231]
    buffer_load_dwordx4 v[108:111], v239, s[36:39], s70 offen sc1
    v_cvt_pk_bf16_f32 v168, v136, v137
    v_cvt_pk_bf16_f32 v169, v138, v139
    v_cvt_pk_bf16_f32 v170, v140, v141
    v_cvt_pk_bf16_f32 v171, v142, v143
    s_waitcnt vmcnt(7)
    v_cvt_pk_bf16_f32 v208, v64, v65
    v_cvt_pk_bf16_f32 v209, v66, v67
    s_waitcnt lgkmcnt(7)
    v_mfma_f32_16x16x32_bf16 v[176:179], a[136:139], v[168:171], v[176:179]
    ds_write_b128 v243, v[168:171] offset:2048
    buffer_load_dword v23, v252, s[36:39], s75 offen sc1
    v_permlane16_swap_b32 v208, v210
    v_rcp_f32 v160, v160
    v_permlane16_swap_b32 v209, v211
    v_pk_mul_f32 v[152:153], v[152:153], v[160:161] op_sel_hi:[1,0]
    v_pk_mul_f32 v[154:155], v[154:155], v[160:161] op_sel_hi:[1,0]
    v_pk_mul_f32 v[156:157], v[156:157], v[160:161] op_sel_hi:[1,0]
    v_pk_mul_f32 v[158:159], v[158:159], v[160:161] op_sel_hi:[1,0]
    s_waitcnt vmcnt(7)
    v_mfma_f32_32x32x16_bf16 v[136:151], v[208:211], v[96:99], v[216:231]
    s_add_u32 m0, s0, 106496
    s_xor_b32 s1, s73, 294912
    buffer_load_dwordx4 v2, s[16:19], s1 offen offset:0 lds
    v_cvt_pk_bf16_f32 v172, v152, v153
    v_cvt_pk_bf16_f32 v173, v154, v155
    v_cvt_pk_bf16_f32 v174, v156, v157
    v_cvt_pk_bf16_f32 v175, v158, v159
    s_waitcnt vmcnt(7)
    v_cvt_pk_bf16_f32 v212, v68, v69
    v_cvt_pk_bf16_f32 v213, v70, v71
    s_waitcnt lgkmcnt(7)
    v_mfma_f32_16x16x32_bf16 v[176:179], a[140:143], v[172:175], v[176:179]
    ds_write_b128 v243, v[172:175] offset:3072
    buffer_load_dwordx4 v3, s[16:19], s1 offen offset:1024 lds
    v_permlane16_swap_b32 v212, v214
    v_rcp_f32 v144, v144
    v_permlane16_swap_b32 v213, v215
    v_pk_mul_f32 v[136:137], v[136:137], v[144:145] op_sel_hi:[1,0]
    v_pk_mul_f32 v[138:139], v[138:139], v[144:145] op_sel_hi:[1,0]
    v_pk_mul_f32 v[140:141], v[140:141], v[144:145] op_sel_hi:[1,0]
    v_pk_mul_f32 v[142:143], v[142:143], v[144:145] op_sel_hi:[1,0]
    s_waitcnt vmcnt(7)
    v_mfma_f32_32x32x16_bf16 v[152:167], v[212:215], v[100:103], v[216:231]
    buffer_load_dwordx4 v4, s[16:19], s1 offen offset:2048 lds
    v_cvt_pk_bf16_f32 v168, v136, v137
    v_cvt_pk_bf16_f32 v169, v138, v139
    v_cvt_pk_bf16_f32 v170, v140, v141
    v_cvt_pk_bf16_f32 v171, v142, v143
    s_waitcnt vmcnt(7)
    v_cvt_pk_bf16_f32 v112, v72, v73
    v_cvt_pk_bf16_f32 v113, v74, v75
    s_waitcnt lgkmcnt(7)
    v_mfma_f32_16x16x32_bf16 v[176:179], a[144:147], v[168:171], v[176:179]
    ds_write_b128 v243, v[168:171] offset:4096
    buffer_load_dwordx4 v5, s[16:19], s1 offen offset:3072 lds
    v_permlane16_swap_b32 v112, v114
    v_permlane16_swap_b32 v113, v115
    v_rcp_f32 v160, v160
    s_nop 0
    v_pk_mul_f32 v[152:153], v[152:153], v[160:161] op_sel_hi:[1,0]
    v_pk_mul_f32 v[154:155], v[154:155], v[160:161] op_sel_hi:[1,0]
    v_pk_mul_f32 v[156:157], v[156:157], v[160:161] op_sel_hi:[1,0]
    v_pk_mul_f32 v[158:159], v[158:159], v[160:161] op_sel_hi:[1,0]
    s_waitcnt vmcnt(7)
    v_mfma_f32_32x32x16_bf16 v[136:151], v[112:115], v[104:107], v[216:231]
    s_add_u32 m0, s0, 110592
    s_xor_b32 s1, s73, 311296
    buffer_load_dwordx4 v2, s[16:19], s1 offen offset:0 lds
    v_cvt_pk_bf16_f32 v172, v152, v153
    v_cvt_pk_bf16_f32 v173, v154, v155
    v_cvt_pk_bf16_f32 v174, v156, v157
    v_cvt_pk_bf16_f32 v175, v158, v159
    s_waitcnt vmcnt(7)
    v_cvt_pk_bf16_f32 v116, v76, v77
    v_cvt_pk_bf16_f32 v117, v78, v79
    s_waitcnt lgkmcnt(7)
    v_mfma_f32_16x16x32_bf16 v[176:179], a[148:151], v[172:175], v[176:179]
    ds_write_b128 v243, v[172:175] offset:5120
    buffer_load_dwordx4 v3, s[16:19], s1 offen offset:1024 lds
    v_permlane16_swap_b32 v116, v118
    v_permlane16_swap_b32 v117, v119
    v_rcp_f32 v144, v144
    s_nop 0
    v_pk_mul_f32 v[136:137], v[136:137], v[144:145] op_sel_hi:[1,0]
    v_pk_mul_f32 v[138:139], v[138:139], v[144:145] op_sel_hi:[1,0]
    v_pk_mul_f32 v[140:141], v[140:141], v[144:145] op_sel_hi:[1,0]
    v_pk_mul_f32 v[142:143], v[142:143], v[144:145] op_sel_hi:[1,0]
    s_waitcnt vmcnt(7)
    v_mfma_f32_32x32x16_bf16 v[152:167], v[116:119], v[108:111], v[216:231]
    buffer_load_dwordx4 v4, s[16:19], s1 offen offset:2048 lds
    v_cvt_pk_bf16_f32 v168, v136, v137
    v_cvt_pk_bf16_f32 v169, v138, v139
    v_cvt_pk_bf16_f32 v170, v140, v141
    v_cvt_pk_bf16_f32 v171, v142, v143
    s_waitcnt lgkmcnt(7)
    s_nop 0
    v_mfma_f32_16x16x32_bf16 v[176:179], a[152:155], v[168:171], v[176:179]
    ds_write_b128 v243, v[168:171] offset:6144
    buffer_load_dwordx4 v5, s[16:19], s1 offen offset:3072 lds
    s_waitcnt vmcnt(8)
    v_cmp_gt_u32 vcc, 16, v23
    s_nop 0
    s_and_b32 vcc_lo, vcc_lo, 0xffff
    s_cbranch_scc1 L_rare10
L_back10:
    v_rcp_f32 v160, v160
    s_nop 0
    v_pk_mul_f32 v[152:153], v[152:153], v[160:161] op_sel_hi:[1,0]
    v_pk_mul_f32 v[154:155], v[154:155], v[160:161] op_sel_hi:[1,0]
    v_pk_mul_f32 v[156:157], v[156:157], v[160:161] op_sel_hi:[1,0]
    v_pk_mul_f32 v[158:159], v[158:159], v[160:161] op_sel_hi:[1,0]
    buffer_load_dwordx4 a[160:163], v7, s[36:39], s4 offen offset:0 sc1
    v_cvt_pk_bf16_f32 v172, v152, v153
    v_cvt_pk_bf16_f32 v173, v154, v155
    v_cvt_pk_bf16_f32 v174, v156, v157
    v_cvt_pk_bf16_f32 v175, v158, v159
    s_mov_b32 vcc_lo, 0xffff0000
    s_mov_b32 vcc_hi, 0xffff0000
    s_waitcnt lgkmcnt(7)
    v_mfma_f32_16x16x32_bf16 v[176:179], a[156:159], v[172:175], v[176:179]
    ds_write_b128 v243, v[172:175] offset:7168
    buffer_load_dwordx4 a[164:167], v7, s[36:39], s20 offen offset:0 sc1
    s_nop 5
    v_cndmask_b32 v176, v176, v177, vcc
    ds_write_b32 v245, v176
    s_waitcnt lgkmcnt(0)
    s_barrier
    ds_read_b128 v[192:195], v244 offset:0
    ds_read_b128 v[196:199], v244 offset:4096
    ds_read_b128 v[200:203], v244 offset:8192
    ds_read_b128 v[204:207], v244 offset:12288
    ds_read_b128 v[208:211], v244 offset:1024
    s_waitcnt lgkmcnt(4)
    v_mfma_f32_32x32x16_bf16 v[24:39], a[0:3], v[192:195], v[24:39]
    s_add_u32 m0, s67, 0
    s_add_u32 s1, s43, 0
    ds_read_b128 v[212:215], v244 offset:5120
    ds_read2_b32 v[48:49], v246 offset0:0 offset1:16
    ds_read2_b32 v[50:51], v246 offset0:32 offset1:48
    buffer_load_dwordx4 v16, s[36:39], s1 offen offset:0 sc1 lds
    s_waitcnt lgkmcnt(6)
    v_mfma_f32_32x32x16_bf16 v[24:39], a[16:19], v[196:199], v[24:39]
    ds_read_b128 v[192:195], v244 offset:9216
    s_waitcnt lgkmcnt(6)
    v_mfma_f32_32x32x16_bf16 v[24:39], a[32:35], v[200:203], v[24:39]
    ds_read_b128 v[196:199], v244 offset:13312
    buffer_load_dwordx4 v16, s[36:39], s1 offen offset:1024 sc1 lds
    s_waitcnt lgkmcnt(6)
    v_mfma_f32_32x32x16_bf16 v[24:39], a[48:51], v[204:207], v[24:39]
    ds_read_b128 v[200:203], v244 offset:2048
    s_waitcnt lgkmcnt(6)
    v_mfma_f32_32x32x16_bf16 v[24:39], a[4:7], v[208:211], v[24:39]
    ds_read_b128 v[204:207], v244 offset:6144
    buffer_load_dwordx4 v16, s[36:39], s1 offen offset:2048 sc1 lds
    s_waitcnt lgkmcnt(6)
    v_mfma_f32_32x32x16_bf16 v[24:39], a[20:23], v[212:215], v[24:39]
    ds_read_b128 v[208:211], v244 offset:10240
    s_waitcnt lgkmcnt(4)
    v_mfma_f32_32x32x16_bf16 v[24:39], a[36:39], v[192:195], v[24:39]
    ds_read_b128 v[212:215], v244 offset:14336
    buffer_load_dwordx4 v16, s[36:39], s1 offen offset:3072 sc1 lds
    s_waitcnt lgkmcnt(4)
    v_mfma_f32_32x32x16_bf16 v[24:39], a[52:55], v[196:199], v[24:39]
    ds_read_b128 v[192:195], v244 offset:3072
    s_waitcnt lgkmcnt(4)
    v_mfma_f32_32x32x16_bf16 v[24:39], a[8:11], v[200:203], v[24:39]
    s_add_u32 m0, s67, 16384
    s_add_u32 s1, s53, 0
    ds_read_b128 v[196:199], v244 offset:7168
    buffer_load_dwordx4 v16, s[36:39], s1 offen offset:0 sc1 lds
    s_waitcnt lgkmcnt(4)
    v_mfma_f32_32x32x16_bf16 v[24:39], a[24:27], v[204:207], v[24:39]
    ds_read_b128 v[200:203], v244 offset:11264
    s_waitcnt lgkmcnt(4)
    v_mfma_f32_32x32x16_bf16 v[24:39], a[40:43], v[208:211], v[24:39]
    ds_read_b128 v[204:207], v244 offset:15360
    buffer_load_dwordx4 v16, s[36:39], s1 offen offset:1024 sc1 lds
    s_waitcnt lgkmcnt(4)
    v_mfma_f32_32x32x16_bf16 v[24:39], a[56:59], v[212:215], v[24:39]
    ds_read_b128 v[208:211], v244 offset:16384
    s_waitcnt vmcnt(12)
    s_barrier
    ds_read_b64_tr_b16 a[64:65], v237 offset:0
    ds_read_b64_tr_b16 a[66:67], v237 offset:512
    s_waitcnt lgkmcnt(6)
    v_mfma_f32_32x32x16_bf16 v[24:39], a[12:15], v[192:195], v[24:39]
    ds_read_b128 v[212:215], v244 offset:20480
    buffer_load_dwordx4 v16, s[36:39], s1 offen offset:2048 sc1 lds
    ds_read_b64_tr_b16 a[80:81], v237 offset:16384
    ds_read_b64_tr_b16 a[82:83], v237 offset:16896
    s_waitcnt lgkmcnt(8)
    v_mfma_f32_32x32x16_bf16 v[24:39], a[28:31], v[196:199], v[24:39]
    ds_read_b128 v[192:195], v244 offset:24576
    ds_read_b64_tr_b16 a[96:97], v237 offset:32768
    ds_read_b64_tr_b16 a[98:99], v237 offset:33280
    s_waitcnt lgkmcnt(10)
    v_mfma_f32_32x32x16_bf16 v[24:39], a[44:47], v[200:203], v[24:39]
    ds_read_b128 v[196:199], v244 offset:28672
    buffer_load_dwordx4 v16, s[36:39], s1 offen offset:3072 sc1 lds
    ds_read_b64_tr_b16 a[112:113], v237 offset:49152
    ds_read_b64_tr_b16 a[114:115], v237 offset:49664
    s_waitcnt lgkmcnt(12)
    v_mfma_f32_32x32x16_bf16 v[24:39], a[60:63], v[204:207], v[24:39]
    ds_read_b128 v[200:203], v244 offset:17408
    ds_read_b64_tr_b16 a[68:69], v237 offset:4096
    ds_read_b64_tr_b16 a[70:71], v237 offset:4608
    s_waitcnt lgkmcnt(12)
    v_mfma_f32_32x32x16_bf16 v[24:39], a[64:67], v[208:211], v[24:39]
    s_add_u32 m0, s67, 32768
    s_add_u32 s1, s43, 32768
    ds_read_b128 v[204:207], v244 offset:21504
    buffer_load_dwordx4 v16, s[36:39], s1 offen offset:0 sc1 lds
    ds_read_b64_tr_b16 a[84:85], v237 offset:20480
    ds_read_b64_tr_b16 a[86:87], v237 offset:20992
    s_waitcnt lgkmcnt(12)
    v_mfma_f32_32x32x16_bf16 v[24:39], a[80:83], v[212:215], v[24:39]
    ds_read_b128 v[208:211], v244 offset:25600
    ds_read_b64_tr_b16 a[100:101], v237 offset:36864
    ds_read_b64_tr_b16 a[102:103], v237 offset:37376
    s_waitcnt lgkmcnt(12)
    v_mfma_f32_32x32x16_bf16 v[24:39], a[96:99], v[192:195], v[24:39]
    ds_read_b128 v[212:215], v244 offset:29696
    buffer_load_dwordx4 v16, s[36:39], s1 offen offset:1024 sc1 lds
    ds_read_b64_tr_b16 a[116:117], v237 offset:53248
    ds_read_b64_tr_b16 a[118:119], v237 offset:53760
    s_waitcnt lgkmcnt(12)
    v_mfma_f32_32x32x16_bf16 v[24:39], a[112:115], v[196:199], v[24:39]
    ds_read_b128 v[192:195], v244 offset:18432
    ds_read_b64_tr_b16 a[72:73], v237 offset:8192
    ds_read_b64_tr_b16 a[74:75], v237 offset:8704
    s_waitcnt lgkmcnt(12)
    v_mfma_f32_32x32x16_bf16 v[24:39], a[68:71], v[200:203], v[24:39]
    ds_read_b128 v[196:199], v244 offset:22528
    buffer_load_dwordx4 v16, s[36:39], s1 offen offset:2048 sc1 lds
    ds_read_b64_tr_b16 a[88:89], v237 offset:24576
    ds_read_b64_tr_b16 a[90:91], v237 offset:25088
    s_waitcnt lgkmcnt(12)
    v_mfma_f32_32x32x16_bf16 v[24:39], a[84:87], v[204:207], v[24:39]
    ds_read_b128 v[200:203], v244 offset:26624
    ds_read_b64_tr_b16 a[104:105], v237 offset:40960
    ds_read_b64_tr_b16 a[106:107], v237 offset:41472
    s_waitcnt lgkmcnt(12)
    v_mfma_f32_32x32x16_bf16 v[24:39], a[100:103], v[208:211], v[24:39]
    ds_read_b128 v[204:207], v244 offset:30720
    buffer_load_dwordx4 v16, s[36:39], s1 offen offset:3072 sc1 lds
    ds_read_b64_tr_b16 a[120:121], v237 offset:57344
    ds_read_b64_tr_b16 a[122:123], v237 offset:57856
    s_waitcnt lgkmcnt(12)
    v_mfma_f32_32x32x16_bf16 v[24:39], a[116:119], v[212:215], v[24:39]
    ds_read_b128 v[208:211], v244 offset:19456
    s_waitcnt vmcnt(14)
    s_barrier
    ds_read_b64_tr_b16 a[76:77], v237 offset:12288
    ds_read_b64_tr_b16 a[78:79], v237 offset:12800
    s_waitcnt lgkmcnt(12)
    v_mfma_f32_32x32x16_bf16 v[24:39], a[72:75], v[192:195], v[24:39]
    ds_read_b128 v[212:215], v244 offset:23552
    buffer_load_dwordx4 a[168:171], v7, s[36:39], s4 offen offset:256 sc1
    ds_read_b64_tr_b16 a[92:93], v237 offset:28672
    ds_read_b64_tr_b16 a[94:95], v237 offset:29184
    s_waitcnt lgkmcnt(12)
    v_mfma_f32_32x32x16_bf16 v[24:39], a[88:91], v[196:199], v[24:39]
    ds_read_b128 v[192:195], v244 offset:27648
    ds_read_b64_tr_b16 a[108:109], v237 offset:45056
    ds_read_b64_tr_b16 a[110:111], v237 offset:45568
    s_waitcnt lgkmcnt(12)
    v_mfma_f32_32x32x16_bf16 v[24:39], a[104:107], v[200:203], v[24:39]
    ds_read_b128 v[196:199], v244 offset:31744
    buffer_load_dwordx4 a[172:175], v7, s[36:39], s20 offen offset:256 sc1
    ds_read_b64_tr_b16 a[124:125], v237 offset:61440
    ds_read_b64_tr_b16 a[126:127], v237 offset:61952
    v_add_f32 v48, v48, v49
    v_add_f32 v50, v50, v51
    v_add_f32 v48, v48, v50
    v_add_f32 v42, v42, v48
    s_waitcnt lgkmcnt(12)
    v_mfma_f32_32x32x16_bf16 v[24:39], a[120:123], v[204:207], v[24:39]
    s_waitcnt lgkmcnt(9)
    v_mfma_f32_32x32x16_bf16 v[24:39], a[76:79], v[208:211], v[24:39]
    buffer_load_dwordx4 a[176:179], v7, s[36:39], s6 offen offset:0 sc1
    s_waitcnt lgkmcnt(6)
    v_mfma_f32_32x32x16_bf16 v[24:39], a[92:95], v[212:215], v[24:39]
    s_waitcnt lgkmcnt(3)
    v_mfma_f32_32x32x16_bf16 v[24:39], a[108:111], v[192:195], v[24:39]
    buffer_load_dwordx4 a[180:183], v7, s[36:39], s21 offen offset:0 sc1
    s_waitcnt lgkmcnt(0)
    v_mfma_f32_32x32x16_bf16 v[24:39], a[124:127], v[196:199], v[24:39]
    s_nop 11
    v_pk_add_f32 v[24:25], v[24:25], v[48:49] op_sel_hi:[1,0] neg_lo:[0,1] neg_hi:[0,1]
    v_cvt_pk_bf16_f32 v52, v24, v25
    v_pk_add_f32 v[26:27], v[26:27], v[48:49] op_sel_hi:[1,0] neg_lo:[0,1] neg_hi:[0,1]
    v_cvt_pk_bf16_f32 v53, v26, v27
    v_pk_add_f32 v[28:29], v[28:29], v[48:49] op_sel_hi:[1,0] neg_lo:[0,1] neg_hi:[0,1]
    v_cvt_pk_bf16_f32 v54, v28, v29
    v_pk_add_f32 v[30:31], v[30:31], v[48:49] op_sel_hi:[1,0] neg_lo:[0,1] neg_hi:[0,1]
    v_cvt_pk_bf16_f32 v55, v30, v31
    buffer_store_dwordx4 v[52:55], v247, s[36:39], 0 offen sc1
    v_pk_add_f32 v[32:33], v[32:33], v[48:49] op_sel_hi:[1,0] neg_lo:[0,1] neg_hi:[0,1]
    v_cvt_pk_bf16_f32 v56, v32, v33
    v_pk_add_f32 v[34:35], v[34:35], v[48:49] op_sel_hi:[1,0] neg_lo:[0,1] neg_hi:[0,1]
    v_cvt_pk_bf16_f32 v57, v34, v35
    v_pk_add_f32 v[36:37], v[36:37], v[48:49] op_sel_hi:[1,0] neg_lo:[0,1] neg_hi:[0,1]
    v_cvt_pk_bf16_f32 v58, v36, v37
    v_pk_add_f32 v[38:39], v[38:39], v[48:49] op_sel_hi:[1,0] neg_lo:[0,1] neg_hi:[0,1]
    v_cvt_pk_bf16_f32 v59, v38, v39
    buffer_store_dwordx4 v[56:59], v247, s[36:39], 0 offen offset:1024 sc1
    v_pk_mul_f32 v[50:51], v[24:25], v[24:25]
    v_pk_fma_f32 v[50:51], v[26:27], v[26:27], v[50:51]
    v_pk_fma_f32 v[50:51], v[28:29], v[28:29], v[50:51]
    v_pk_fma_f32 v[50:51], v[30:31], v[30:31], v[50:51]
    v_pk_fma_f32 v[50:51], v[32:33], v[32:33], v[50:51]
    v_pk_fma_f32 v[50:51], v[34:35], v[34:35], v[50:51]
    v_pk_fma_f32 v[50:51], v[36:37], v[36:37], v[50:51]
    v_pk_fma_f32 v[50:51], v[38:39], v[38:39], v[50:51]
    v_add_f32 v50, v50, v51
    s_nop 1
    v_permlane32_swap_b32 v50, v42
    s_mov_b32 exec_hi, 0
    v_add_f32 v50, v50, v42
    s_mov_b32 exec_hi, -1
    buffer_store_dword v50, v248, s[36:39], 0 offen sc1
    s_barrier
    s_getpc_b64 s[48:49]
L_pc11:
    s_lshl2_add_u32 s47, s45, s3
    s_lshl_b32 s47, s47, 8
    v_add_u32 v60, s47, v17
    v_min_u32 v60, L_last-L_pc11, v60
    global_load_dword v15, v60, s[48:49]
    s_add_u32 m0, s67, 49152
    s_add_u32 s1, s53, 32768
    buffer_load_dwordx4 v16, s[36:39], s1 offen offset:0 sc1 lds
    buffer_load_dwordx4 v16, s[36:39], s1 offen offset:1024 sc1 lds
    buffer_load_dwordx4 v16, s[36:39], s1 offen offset:2048 sc1 lds
    buffer_load_dwordx4 v16, s[36:39], s1 offen offset:3072 sc1 lds
    s_add_u32 m0, s67, 65536
    s_add_u32 s1, s43, 65536
    buffer_load_dwordx4 v16, s[36:39], s1 offen offset:0 sc1 lds
    buffer_load_dwordx4 v16, s[36:39], s1 offen offset:1024 sc1 lds
    buffer_load_dwordx4 v16, s[36:39], s1 offen offset:2048 sc1 lds
    buffer_load_dwordx4 v16, s[36:39], s1 offen offset:3072 sc1 lds
    s_add_u32 m0, s67, 81920
    s_add_u32 s1, s53, 65536
    buffer_load_dwordx4 v16, s[36:39], s1 offen offset:0 sc1 lds
    s_waitcnt vmcnt(10)
    s_atomic_add s76, s[36:37], s64
    buffer_load_dwordx4 v16, s[36:39], s1 offen offset:1024 sc1 lds
    buffer_load_dwordx4 v16, s[36:39], s1 offen offset:2048 sc1 lds
    buffer_load_dwordx4 v16, s[36:39], s1 offen offset:3072 sc1 lds
    s_add_u32 m0, s67, 98304
    s_add_u32 s1, s43, 98304
    buffer_load_dwordx4 v16, s[36:39], s1 offen offset:0 sc1 lds
    buffer_load_dwordx4 v16, s[36:39], s1 offen offset:1024 sc1 lds
    buffer_load_dwordx4 v16, s[36:39], s1 offen offset:2048 sc1 lds
    buffer_load_dwordx4 v16, s[36:39], s1 offen offset:3072 sc1 lds
    s_add_u32 m0, s67, 114688
    s_add_u32 s1, s53, 98304
    buffer_load_dwordx4 v16, s[36:39], s1 offen offset:0 sc1 lds
    s_mov_b32 s57, 0
    s_atomic_add s57, s[36:37], s42 offset:0x0 glc
    buffer_load_dwordx4 v16, s[36:39], s1 offen offset:1024 sc1 lds
    buffer_load_dwordx4 v16, s[36:39], s1 offen offset:2048 sc1 lds
    buffer_load_dwordx4 v16, s[36:39], s1 offen offset:3072 sc1 lds
    s_waitcnt lgkmcnt(0)
    s_cmp_lt_u32 s57, 16
    s_cbranch_scc1 L_rare12
L_back12:
    s_add_u32 s24, s25, s26
    buffer_load_dwordx4 v[128:131], v6, s[36:39], s24 offen offset:0 sc1
    buffer_load_dwordx4 v[132:135], v6, s[36:39], s24 offen offset:256 sc1
    s_add_u32 s26, s26, 4096
    buffer_load_dwordx4 v[136:139], v6, s[36:39], s24 offen offset:2048 sc1
    s_and_b32 s26, s26, 0x7fff
    buffer_load_dwordx4 v[140:143], v6, s[36:39], s24 offen offset:2304 sc1
    s_add_u32 s24, s25, s26
    buffer_load_dwordx4 v[144:147], v6, s[36:39], s24 offen offset:0 sc1
    buffer_load_dwordx4 v[148:151], v6, s[36:39], s24 offen offset:256 sc1
    s_add_u32 s26, s26, 4096
    buffer_load_dwordx4 v[152:155], v6, s[36:39], s24 offen offset:2048 sc1
    s_and_b32 s26, s26, 0x7fff
    buffer_load_dwordx4 v[156:159], v6, s[36:39], s24 offen offset:2304 sc1
    s_add_u32 s24, s25, s26
    buffer_load_dwordx4 v[160:163], v6, s[36:39], s24 offen offset:0 sc1
    buffer_load_dwordx4 v[164:167], v6, s[36:39], s24 offen offset:256 sc1
    s_add_u32 s26, s26, 4096
    s_waitcnt vmcnt(10)
    s_barrier
    ds_read_b128 v[40:43], v6 offset:0
    ds_read_b128 v[44:47], v6 offset:2048
    ds_read_b128 v[48:51], v6 offset:256
    ds_read_b128 v[52:55], v6 offset:2304
    s_waitcnt lgkmcnt(2)
    s_waitcnt vmcnt(9)
    v_mfma_f32_16x16x32_bf16 v[64:67], v[40:43], v[128:131], 0
    ds_read_b128 v[56:59], v6 offset:32768
    ds_read_b128 v[60:63], v6 offset:34816
    s_waitcnt vmcnt(7)
    v_mfma_f32_16x16x32_bf16 v[64:67], v[44:47], v[136:139], v[64:67]
    s_and_b32 s26, s26, 0x7fff
    buffer_load_dwordx4 v[168:171], v6, s[36:39], s24 offen offset:2048 sc1
    v_mfma_f32_16x16x32_bf16 v[68:71], v[40:43], v[132:135], 0
    s_waitcnt vmcnt(7)
    v_mfma_f32_16x16x32_bf16 v[68:71], v[44:47], v[140:143], v[68:71]
    s_waitcnt lgkmcnt(2)
    v_mfma_f32_16x16x32_bf16 v[72:75], v[48:51], v[128:131], 0
    ds_read_b128 v[40:43], v6 offset:33024
    ds_read_b128 v[44:47], v6 offset:35072
    v_mfma_f32_16x16x32_bf16 v[72:75], v[52:55], v[136:139], v[72:75]
    buffer_load_dwordx4 v[172:175], v6, s[36:39], s24 offen offset:2304 sc1
    v_mfma_f32_16x16x32_bf16 v[76:79], v[48:51], v[132:135], 0
    v_and_b32 v14, 31, v0
    v_lshlrev_b32 v14, 2, v14
    v_mfma_f32_16x16x32_bf16 v[76:79], v[52:55], v[140:143], v[76:79]
    s_waitcnt lgkmcnt(2)
    v_mfma_f32_16x16x32_bf16 v[80:83], v[56:59], v[128:131], 0
    ds_read_b128 v[48:51], v8 offset:0
    ds_read_b128 v[52:55], v8 offset:2048
    v_mfma_f32_16x16x32_bf16 v[80:83], v[60:63], v[136:139], v[80:83]
    s_add_u32 s24, s25, s26
    buffer_load_dwordx4 v[176:179], v6, s[36:39], s24 offen offset:0 sc1
    v_mfma_f32_16x16x32_bf16 v[84:87], v[56:59], v[132:135], 0
    v_mfma_f32_16x16x32_bf16 v[84:87], v[60:63], v[140:143], v[84:87]
    s_waitcnt lgkmcnt(2)
    v_mfma_f32_16x16x32_bf16 v[88:91], v[40:43], v[128:131], 0
    ds_read_b128 v[56:59], v8 offset:256
    ds_read_b128 v[60:63], v8 offset:2304
    v_mfma_f32_16x16x32_bf16 v[88:91], v[44:47], v[136:139], v[88:91]
    s_add_u32 s26, s26, 4096
    buffer_load_dwordx4 v[180:183], v6, s[36:39], s24 offen offset:256 sc1
    v_mfma_f32_16x16x32_bf16 v[92:95], v[40:43], v[132:135], 0
    v_mfma_f32_16x16x32_bf16 v[92:95], v[44:47], v[140:143], v[92:95]
    s_waitcnt lgkmcnt(2)
    v_mfma_f32_16x16x32_bf16 v[96:99], v[48:51], v[128:131], 0
    ds_read_b128 v[40:43], v6 offset:4096
    ds_read_b128 v[44:47], v6 offset:6144
    v_mfma_f32_16x16x32_bf16 v[96:99], v[52:55], v[136:139], v[96:99]
    s_and_b32 s26, s26, 0x7fff
    buffer_load_dwordx4 v[184:187], v6, s[36:39], s24 offen offset:2048 sc1
    v_mfma_f32_16x16x32_bf16 v[100:103], v[48:51], v[132:135], 0
    v_mfma_f32_16x16x32_bf16 v[100:103], v[52:55], v[140:143], v[100:103]
    s_waitcnt lgkmcnt(2)
    v_mfma_f32_16x16x32_bf16 v[104:107], v[56:59], v[128:131], 0
    ds_read_b128 v[48:51], v6 offset:4352
    ds_read_b128 v[52:55], v6 offset:6400
    v_mfma_f32_16x16x32_bf16 v[104:107], v[60:63], v[136:139], v[104:107]
    buffer_load_dwordx4 v[188:191], v6, s[36:39], s24 offen offset:2304 sc1
    v_mfma_f32_16x16x32_bf16 v[108:111], v[56:59], v[132:135], 0
    v_mfma_f32_16x16x32_bf16 v[108:111], v[60:63], v[140:143], v[108:111]
    s_waitcnt lgkmcnt(2)
    s_waitcnt vmcnt(10)
    v_mfma_f32_16x16x32_bf16 v[68:71], v[40:43], v[148:151], v[68:71]
    ds_read_b128 v[56:59], v6 offset:36864
    ds_read_b128 v[60:63], v6 offset:38912
    s_waitcnt vmcnt(8)
    v_mfma_f32_16x16x32_bf16 v[68:71], v[44:47], v[156:159], v[68:71]
    s_add_u32 s24, s25, s26
    buffer_load_dwordx4 v[192:195], v6, s[36:39], s24 offen offset:0 sc1
    v_mfma_f32_16x16x32_bf16 v[64:67], v[40:43], v[144:147], v[64:67]
    v_mfma_f32_16x16x32_bf16 v[64:67], v[44:47], v[152:155], v[64:67]
    s_waitcnt lgkmcnt(2)
    v_mfma_f32_16x16x32_bf16 v[76:79], v[48:51], v[148:151], v[76:79]
    ds_read_b128 v[40:43], v6 offset:37120
    ds_read_b128 v[44:47], v6 offset:39168
    v_mfma_f32_16x16x32_bf16 v[76:79], v[52:55], v[156:159], v[76:79]
    s_add_u32 s26, s26, 4096
    buffer_load_dwordx4 v[196:199], v6, s[36:39], s24 offen offset:256 sc1
    v_mfma_f32_16x16x32_bf16 v[72:75], v[48:51], v[144:147], v[72:75]
    v_mfma_f32_16x16x32_bf16 v[72:75], v[52:55], v[152:155], v[72:75]
    s_waitcnt lgkmcnt(2)
    v_mfma_f32_16x16x32_bf16 v[84:87], v[56:59], v[148:151], v[84:87]
    ds_read_b128 v[48:51], v8 offset:4096
    ds_read_b128 v[52:55], v8 offset:6144
    v_mfma_f32_16x16x32_bf16 v[84:87], v[60:63], v[156:159], v[84:87]
    s_and_b32 s26, s26, 0x7fff
    buffer_load_dwordx4 v[200:203], v6, s[36:39], s24 offen offset:2048 sc1
    v_mfma_f32_16x16x32_bf16 v[80:83], v[56:59], v[144:147], v[80:83]
    v_mfma_f32_16x16x32_bf16 v[80:83], v[60:63], v[152:155], v[80:83]
    s_waitcnt lgkmcnt(2)
    v_mfma_f32_16x16x32_bf16 v[92:95], v[40:43], v[148:151], v[92:95]
    ds_read_b128 v[56:59], v8 offset:4352
    ds_read_b128 v[60:63], v8 offset:6400
    v_mfma_f32_16x16x32_bf16 v[92:95], v[44:47], v[156:159], v[92:95]
    buffer_load_dwordx4 v[204:207], v6, s[36:39], s24 offen offset:2304 sc1
    v_mfma_f32_16x16x32_bf16 v[88:91], v[40:43], v[144:147], v[88:91]
    v_mfma_f32_16x16x32_bf16 v[88:91], v[44:47], v[152:155], v[88:91]
    s_waitcnt lgkmcnt(2)
    v_mfma_f32_16x16x32_bf16 v[100:103], v[48:51], v[148:151], v[100:103]
    ds_read_b128 v[40:43], v6 offset:8192
    ds_read_b128 v[44:47], v6 offset:10240
    v_mfma_f32_16x16x32_bf16 v[100:103], v[52:55], v[156:159], v[100:103]
    s_add_u32 s24, s25, s26
    buffer_load_dwordx4 v[208:211], v6, s[36:39], s24 offen offset:0 sc1
    v_mfma_f32_16x16x32_bf16 v[96:99], v[48:51], v[144:147], v[96:99]
    v_mfma_f32_16x16x32_bf16 v[96:99], v[52:55], v[152:155], v[96:99]
    s_waitcnt lgkmcnt(2)
    v_mfma_f32_16x16x32_bf16 v[108:111], v[56:59], v[148:151], v[108:111]
    ds_read_b128 v[48:51], v6 offset:8448
    ds_read_b128 v[52:55], v6 offset:10496
    v_mfma_f32_16x16x32_bf16 v[108:111], v[60:63], v[156:159], v[108:111]
    s_add_u32 s26, s26, 4096
    buffer_load_dwordx4 v[212:215], v6, s[36:39], s24 offen offset:256 sc1
    v_mfma_f32_16x16x32_bf16 v[104:107], v[56:59], v[144:147], v[104:107]
    v_mfma_f32_16x16x32_bf16 v[104:107], v[60:63], v[152:155], v[104:107]
    s_waitcnt lgkmcnt(2)
    s_waitcnt vmcnt(13)
    v_mfma_f32_16x16x32_bf16 v[64:67], v[40:43], v[160:163], v[64:67]
    ds_read_b128 v[56:59], v6 offset:40960
    ds_read_b128 v[60:63], v6 offset:43008
    s_waitcnt vmcnt(11)
    v_mfma_f32_16x16x32_bf16 v[64:67], v[44:47], v[168:171], v[64:67]
    s_and_b32 s26, s26, 0x7fff
    buffer_load_dwordx4 v[216:219], v6, s[36:39], s24 offen offset:2048 sc1
    v_mfma_f32_16x16x32_bf16 v[68:71], v[40:43], v[164:167], v[68:71]
    s_waitcnt vmcnt(11)
    v_mfma_f32_16x16x32_bf16 v[68:71], v[44:47], v[172:175], v[68:71]
    s_waitcnt lgkmcnt(2)
    v_mfma_f32_16x16x32_bf16 v[72:75], v[48:51], v[160:163], v[72:75]
    ds_read_b128 v[40:43], v6 offset:41216
    ds_read_b128 v[44:47], v6 offset:43264
    v_mfma_f32_16x16x32_bf16 v[72:75], v[52:55], v[168:171], v[72:75]
    buffer_load_dwordx4 v[220:223], v6, s[36:39], s24 offen offset:2304 sc1
    v_mfma_f32_16x16x32_bf16 v[76:79], v[48:51], v[164:167], v[76:79]
    v_mfma_f32_16x16x32_bf16 v[76:79], v[52:55], v[172:175], v[76:79]
    s_waitcnt lgkmcnt(2)
    v_mfma_f32_16x16x32_bf16 v[80:83], v[56:59], v[160:163], v[80:83]
    ds_read_b128 v[48:51], v8 offset:8192
    ds_read_b128 v[52:55], v8 offset:10240
    v_mfma_f32_16x16x32_bf16 v[80:83], v[60:63], v[168:171], v[80:83]
    s_add_u32 s24, s25, s26
    buffer_load_dwordx4 v[224:227], v6, s[36:39], s24 offen offset:0 sc1
    v_mfma_f32_16x16x32_bf16 v[84:87], v[56:59], v[164:167], v[84:87]
    v_mfma_f32_16x16x32_bf16 v[84:87], v[60:63], v[172:175], v[84:87]
    s_waitcnt lgkmcnt(2)
    v_mfma_f32_16x16x32_bf16 v[88:91], v[40:43], v[160:163], v[88:91]
    ds_read_b128 v[56:59], v8 offset:8448
    ds_read_b128 v[60:63], v8 offset:10496
    v_mfma_f32_16x16x32_bf16 v[88:91], v[44:47], v[168:171], v[88:91]
    s_add_u32 s26, s26, 4096
    buffer_load_dwordx4 v[228:231], v6, s[36:39], s24 offen offset:256 sc1
    v_mfma_f32_16x16x32_bf16 v[92:95], v[40:43], v[164:167], v[92:95]
    v_mfma_f32_16x16x32_bf16 v[92:95], v[44:47], v[172:175], v[92:95]
    s_waitcnt lgkmcnt(2)
    v_mfma_f32_16x16x32_bf16 v[96:99], v[48:51], v[160:163], v[96:99]
    ds_read_b128 v[40:43], v6 offset:12288
    ds_read_b128 v[44:47], v6 offset:14336
    v_mfma_f32_16x16x32_bf16 v[96:99], v[52:55], v[168:171], v[96:99]
    s_and_b32 s26, s26, 0x7fff
    buffer_load_dwordx4 v[232:235], v6, s[36:39], s24 offen offset:2048 sc1
    v_mfma_f32_16x16x32_bf16 v[100:103], v[48:51], v[164:167], v[100:103]
    v_mfma_f32_16x16x32_bf16 v[100:103], v[52:55], v[172:175], v[100:103]
    s_waitcnt lgkmcnt(2)
    v_mfma_f32_16x16x32_bf16 v[104:107], v[56:59], v[160:163], v[104:107]
    ds_read_b128 v[48:51], v6 offset:12544
    ds_read_b128 v[52:55], v6 offset:14592
    v_mfma_f32_16x16x32_bf16 v[104:107], v[60:63], v[168:171], v[104:107]
    buffer_load_dwordx4 v[236:239], v6, s[36:39], s24 offen offset:2304 sc1
    v_mfma_f32_16x16x32_bf16 v[108:111], v[56:59], v[164:167], v[108:111]
    v_mfma_f32_16x16x32_bf16 v[108:111], v[60:63], v[172:175], v[108:111]
    s_waitcnt lgkmcnt(2)
    s_waitcnt vmcnt(14)
    v_mfma_f32_16x16x32_bf16 v[68:71], v[40:43], v[180:183], v[68:71]
    ds_read_b128 v[56:59], v6 offset:45056
    ds_read_b128 v[60:63], v6 offset:47104
    s_waitcnt vmcnt(12)
    v_mfma_f32_16x16x32_bf16 v[68:71], v[44:47], v[188:191], v[68:71]
L_pad4:
    s_cbranch_execz L_padret7
    s_add_u32 s24, s25, s26
    buffer_load_dwordx4 v[240:243], v6, s[36:39], s24 offen offset:0 sc1
    v_mfma_f32_16x16x32_bf16 v[64:67], v[40:43], v[176:179], v[64:67]
    v_mfma_f32_16x16x32_bf16 v[64:67], v[44:47], v[184:187], v[64:67]
    s_waitcnt lgkmcnt(2)
    v_mfma_f32_16x16x32_bf16 v[76:79], v[48:51], v[180:183], v[76:79]
    ds_read_b128 v[40:43], v6 offset:45312
    ds_read_b128 v[44:47], v6 offset:47360
    v_mfma_f32_16x16x32_bf16 v[76:79], v[52:55], v[188:191], v[76:79]
    s_add_u32 s26, s26, 4096
    buffer_load_dwordx4 v[244:247], v6, s[36:39], s24 offen offset:256 sc1
    v_mfma_f32_16x16x32_bf16 v[72:75], v[48:51], v[176:179], v[72:75]
    v_mfma_f32_16x16x32_bf16 v[72:75], v[52:55], v[184:187], v[72:75]
    s_waitcnt lgkmcnt(2)
    v_mfma_f32_16x16x32_bf16 v[84:87], v[56:59], v[180:183], v[84:87]
    ds_read_b128 v[48:51], v8 offset:12288
    ds_read_b128 v[52:55], v8 offset:14336
    v_mfma_f32_16x16x32_bf16 v[84:87], v[60:63], v[188:191], v[84:87]
    s_and_b32 s26, s26, 0x7fff
    buffer_load_dwordx4 v[248:251], v6, s[36:39], s24 offen offset:2048 sc1
    v_mfma_f32_16x16x32_bf16 v[80:83], v[56:59], v[176:179], v[80:83]
    v_mfma_f32_16x16x32_bf16 v[80:83], v[60:63], v[184:187], v[80:83]
    s_waitcnt lgkmcnt(2)
    v_mfma_f32_16x16x32_bf16 v[92:95], v[40:43], v[180:183], v[92:95]
    ds_read_b128 v[56:59], v8 offset:12544
    ds_read_b128 v[60:63], v8 offset:14592
    v_mfma_f32_16x16x32_bf16 v[92:95], v[44:47], v[188:191], v[92:95]
    buffer_load_dwordx4 v[252:255], v6, s[36:39], s24 offen offset:2304 sc1
    v_mfma_f32_16x16x32_bf16 v[88:91], v[40:43], v[176:179], v[88:91]
    v_mfma_f32_16x16x32_bf16 v[88:91], v[44:47], v[184:187], v[88:91]
    s_waitcnt lgkmcnt(2)
    v_mfma_f32_16x16x32_bf16 v[100:103], v[48:51], v[180:183], v[100:103]
    ds_read_b128 v[40:43], v6 offset:16384
    ds_read_b128 v[44:47], v6 offset:18432
    v_mfma_f32_16x16x32_bf16 v[100:103], v[52:55], v[188:191], v[100:103]
    buffer_load_dwordx4 v[24:27], v16, s[36:39], s27 offen sc1
    v_mfma_f32_16x16x32_bf16 v[96:99], v[48:51], v[176:179], v[96:99]
    v_mfma_f32_16x16x32_bf16 v[96:99], v[52:55], v[184:187], v[96:99]
    s_waitcnt lgkmcnt(2)
    v_mfma_f32_16x16x32_bf16 v[108:111], v[56:59], v[180:183], v[108:111]
    ds_read_b128 v[48:51], v6 offset:16640
    ds_read_b128 v[52:55], v6 offset:18688
    v_mfma_f32_16x16x32_bf16 v[108:111], v[60:63], v[188:191], v[108:111]
    buffer_load_dwordx4 v[28:31], v16, s[36:39], s27 offen offset:1024 sc1
    v_mfma_f32_16x16x32_bf16 v[104:107], v[56:59], v[176:179], v[104:107]
    v_mfma_f32_16x16x32_bf16 v[104:107], v[60:63], v[184:187], v[104:107]
    s_waitcnt lgkmcnt(2)
    s_waitcnt vmcnt(17)
    v_mfma_f32_16x16x32_bf16 v[64:67], v[40:43], v[192:195], v[64:67]
    ds_read_b128 v[56:59], v6 offset:49152
    ds_read_b128 v[60:63], v6 offset:51200
    s_waitcnt vmcnt(15)
    v_mfma_f32_16x16x32_bf16 v[64:67], v[44:47], v[200:203], v[64:67]
    s_add_u32 m0, s67, 131072
    s_add_u32 s1, s43, 131072
    buffer_load_dwordx4 v16, s[36:39], s1 offen offset:0 sc1 lds
    v_mfma_f32_16x16x32_bf16 v[68:71], v[40:43], v[196:199], v[68:71]
    s_waitcnt vmcnt(15)
    v_mfma_f32_16x16x32_bf16 v[68:71], v[44:47], v[204:207], v[68:71]
    s_waitcnt lgkmcnt(2)
    v_mfma_f32_16x16x32_bf16 v[72:75], v[48:51], v[192:195], v[72:75]
    ds_read_b128 v[40:43], v6 offset:49408
    ds_read_b128 v[44:47], v6 offset:51456
    v_mfma_f32_16x16x32_bf16 v[72:75], v[52:55], v[200:203], v[72:75]
    buffer_load_dwordx4 v16, s[36:39], s1 offen offset:1024 sc1 lds
    v_mfma_f32_16x16x32_bf16 v[76:79], v[48:51], v[196:199], v[76:79]
    v_mfma_f32_16x16x32_bf16 v[76:79], v[52:55], v[204:207], v[76:79]
    s_waitcnt lgkmcnt(2)
    v_mfma_f32_16x16x32_bf16 v[80:83], v[56:59], v[192:195], v[80:83]
    ds_read_b128 v[48:51], v8 offset:16384
    ds_read_b128 v[52:55], v8 offset:18432
    v_mfma_f32_16x16x32_bf16 v[80:83], v[60:63], v[200:203], v[80:83]
    buffer_load_dwordx4 v16, s[36:39], s1 offen offset:2048 sc1 lds
    v_mfma_f32_16x16x32_bf16 v[84:87], v[56:59], v[196:199], v[84:87]
    v_mfma_f32_16x16x32_bf16 v[84:87], v[60:63], v[204:207], v[84:87]
    s_waitcnt lgkmcnt(2)
    v_mfma_f32_16x16x32_bf16 v[88:91], v[40:43], v[192:195], v[88:91]
    ds_read_b128 v[56:59], v8 offset:16640
    ds_read_b128 v[60:63], v8 offset:18688
    v_mfma_f32_16x16x32_bf16 v[88:91], v[44:47], v[200:203], v[88:91]
    buffer_load_dwordx4 v16, s[36:39], s1 offen offset:3072 sc1 lds
    v_mfma_f32_16x16x32_bf16 v[92:95], v[40:43], v[196:199], v[92:95]
    v_mfma_f32_16x16x32_bf16 v[92:95], v[44:47], v[204:207], v[92:95]
    s_waitcnt lgkmcnt(2)
    v_mfma_f32_16x16x32_bf16 v[96:99], v[48:51], v[192:195], v[96:99]
    ds_read_b128 v[40:43], v6 offset:20480
    ds_read_b128 v[44:47], v6 offset:22528
    v_mfma_f32_16x16x32_bf16 v[96:99], v[52:55], v[200:203], v[96:99]
    s_add_u32 m0, s67, 147456
    s_add_u32 s1, s53, 131072
    buffer_load_dwordx4 v16, s[36:39], s1 offen offset:0 sc1 lds
    v_mfma_f32_16x16x32_bf16 v[100:103], v[48:51], v[196:199], v[100:103]
    v_mfma_f32_16x16x32_bf16 v[100:103], v[52:55], v[204:207], v[100:103]
    s_waitcnt lgkmcnt(2)
    v_mfma_f32_16x16x32_bf16 v[104:107], v[56:59], v[192:195], v[104:107]
    ds_read_b128 v[48:51], v6 offset:20736
    ds_read_b128 v[52:55], v6 offset:22784
    v_mfma_f32_16x16x32_bf16 v[104:107], v[60:63], v[200:203], v[104:107]
    buffer_load_dwordx4 v16, s[36:39], s1 offen offset:1024 sc1 lds
    v_mfma_f32_16x16x32_bf16 v[108:111], v[56:59], v[196:199], v[108:111]
    v_mfma_f32_16x16x32_bf16 v[108:111], v[60:63], v[204:207], v[108:111]
    s_waitcnt lgkmcnt(2)
    s_waitcnt vmcnt(18)
    v_mfma_f32_16x16x32_bf16 v[68:71], v[40:43], v[212:215], v[68:71]
    ds_read_b128 v[56:59], v6 offset:53248
    ds_read_b128 v[60:63], v6 offset:55296
    s_waitcnt vmcnt(16)
    v_mfma_f32_16x16x32_bf16 v[68:71], v[44:47], v[220:223], v[68:71]
    buffer_load_dwordx4 v16, s[36:39], s1 offen offset:2048 sc1 lds
    v_mfma_f32_16x16x32_bf16 v[64:67], v[40:43], v[208:211], v[64:67]
    v_mfma_f32_16x16x32_bf16 v[64:67], v[44:47], v[216:219], v[64:67]
    s_waitcnt lgkmcnt(2)
    v_mfma_f32_16x16x32_bf16 v[76:79], v[48:51], v[212:215], v[76:79]
    ds_read_b128 v[40:43], v6 offset:53504
    ds_read_b128 v[44:47], v6 offset:55552
    v_mfma_f32_16x16x32_bf16 v[76:79], v[52:55], v[220:223], v[76:79]
    buffer_load_dwordx4 v16, s[36:39], s1 offen offset:3072 sc1 lds
    v_mfma_f32_16x16x32_bf16 v[72:75], v[48:51], v[208:211], v[72:75]
    v_mfma_f32_16x16x32_bf16 v[72:75], v[52:55], v[216:219], v[72:75]
    s_waitcnt lgkmcnt(2)
    v_mfma_f32_16x16x32_bf16 v[84:87], v[56:59], v[212:215], v[84:87]
    ds_read_b128 v[48:51], v8 offset:20480
    ds_read_b128 v[52:55], v8 offset:22528
    v_mfma_f32_16x16x32_bf16 v[84:87], v[60:63], v[220:223], v[84:87]
    buffer_load_dwordx4 a[184:187], v7, s[36:39], s6 offen offset:256 sc1
    v_mfma_f32_16x16x32_bf16 v[80:83], v[56:59], v[208:211], v[80:83]
    v_mfma_f32_16x16x32_bf16 v[80:83], v[60:63], v[216:219], v[80:83]
    s_waitcnt lgkmcnt(2)
    v_mfma_f32_16x16x32_bf16 v[92:95], v[40:43], v[212:215], v[92:95]
    ds_read_b128 v[56:59], v8 offset:20736
    ds_read_b128 v[60:63], v8 offset:22784
    v_mfma_f32_16x16x32_bf16 v[92:95], v[44:47], v[220:223], v[92:95]
    buffer_load_dwordx4 a[188:191], v7, s[36:39], s21 offen offset:256 sc1
    v_mfma_f32_16x16x32_bf16 v[88:91], v[40:43], v[208:211], v[88:91]
    v_mfma_f32_16x16x32_bf16 v[88:91], v[44:47], v[216:219], v[88:91]
    s_waitcnt lgkmcnt(2)
    v_mfma_f32_16x16x32_bf16 v[100:103], v[48:51], v[212:215], v[100:103]
    ds_read_b128 v[40:43], v6 offset:24576
    ds_read_b128 v[44:47], v6 offset:26624
    v_mfma_f32_16x16x32_bf16 v[100:103], v[52:55], v[220:223], v[100:103]
    buffer_load_dwordx4 a[192:195], v7, s[36:39], s7 offen offset:0 sc1
    v_mfma_f32_16x16x32_bf16 v[96:99], v[48:51], v[208:211], v[96:99]
    v_mfma_f32_16x16x32_bf16 v[96:99], v[52:55], v[216:219], v[96:99]
    s_waitcnt lgkmcnt(2)
    v_mfma_f32_16x16x32_bf16 v[108:111], v[56:59], v[212:215], v[108:111]
    ds_read_b128 v[48:51], v6 offset:24832
    ds_read_b128 v[52:55], v6 offset:26880
    v_mfma_f32_16x16x32_bf16 v[108:111], v[60:63], v[220:223], v[108:111]
    buffer_load_dwordx4 a[196:199], v7, s[36:39], s22 offen offset:0 sc1
    v_mfma_f32_16x16x32_bf16 v[104:107], v[56:59], v[208:211], v[104:107]
    v_mfma_f32_16x16x32_bf16 v[104:107], v[60:63], v[216:219], v[104:107]
    s_waitcnt lgkmcnt(2)
    s_waitcnt vmcnt(21)
    v_mfma_f32_16x16x32_bf16 v[64:67], v[40:43], v[224:227], v[64:67]
    ds_read_b128 v[56:59], v6 offset:57344
    ds_read_b128 v[60:63], v6 offset:59392
    s_waitcnt vmcnt(19)
    v_mfma_f32_16x16x32_bf16 v[64:67], v[44:47], v[232:235], v[64:67]
    buffer_load_dwordx4 a[200:203], v7, s[36:39], s7 offen offset:256 sc1
    v_mfma_f32_16x16x32_bf16 v[68:71], v[40:43], v[228:231], v[68:71]
    s_waitcnt vmcnt(19)
    v_mfma_f32_16x16x32_bf16 v[68:71], v[44:47], v[236:239], v[68:71]
    s_waitcnt lgkmcnt(2)
    v_mfma_f32_16x16x32_bf16 v[72:75], v[48:51], v[224:227], v[72:75]
    ds_read_b128 v[40:43], v6 offset:57600
    ds_read_b128 v[44:47], v6 offset:59648
    v_mfma_f32_16x16x32_bf16 v[72:75], v[52:55], v[232:235], v[72:75]
    buffer_load_dwordx4 a[204:207], v7, s[36:39], s22 offen offset:256 sc1
    v_mfma_f32_16x16x32_bf16 v[76:79], v[48:51], v[228:231], v[76:79]
    v_mfma_f32_16x16x32_bf16 v[76:79], v[52:55], v[236:239], v[76:79]
    s_waitcnt lgkmcnt(2)
    v_mfma_f32_16x16x32_bf16 v[80:83], v[56:59], v[224:227], v[80:83]
    ds_read_b128 v[48:51], v8 offset:24576
    ds_read_b128 v[52:55], v8 offset:26624
    v_mfma_f32_16x16x32_bf16 v[80:83], v[60:63], v[232:235], v[80:83]
    buffer_load_dwordx4 a[208:211], v7, s[36:39], s44 offen offset:0 sc1
    s_waitcnt vmcnt(15)
    v_add_f32 v24, v24, v28
    v_add_f32 v25, v25, v29
    v_add_f32 v26, v26, v30
    v_add_f32 v27, v27, v31
    v_mfma_f32_16x16x32_bf16 v[84:87], v[56:59], v[228:231], v[84:87]
    v_add_f32_dpp v24, v24, v24 row_ror:8 row_mask:0xf bank_mask:0xf
    v_add_f32_dpp v25, v25, v25 row_ror:8 row_mask:0xf bank_mask:0xf
    v_mfma_f32_16x16x32_bf16 v[84:87], v[60:63], v[236:239], v[84:87]
    s_waitcnt lgkmcnt(2)
    v_add_f32_dpp v26, v26, v26 row_ror:8 row_mask:0xf bank_mask:0xf
    v_add_f32_dpp v27, v27, v27 row_ror:8 row_mask:0xf bank_mask:0xf
    v_mfma_f32_16x16x32_bf16 v[88:91], v[40:43], v[224:227], v[88:91]
    ds_read_b128 v[56:59], v8 offset:24832
    ds_read_b128 v[60:63], v8 offset:26880
    v_mfma_f32_16x16x32_bf16 v[88:91], v[44:47], v[232:235], v[88:91]
    buffer_load_dwordx4 a[212:215], v7, s[36:39], s23 offen offset:0 sc1
    v_mov_b32 v28, v24
    v_mov_b32 v29, v25
    v_mov_b32 v30, v26
    v_mov_b32 v31, v27
    v_mfma_f32_16x16x32_bf16 v[92:95], v[40:43], v[228:231], v[92:95]
    v_permlane16_swap_b32 v24, v28
    v_mfma_f32_16x16x32_bf16 v[92:95], v[44:47], v[236:239], v[92:95]
    s_waitcnt lgkmcnt(2)
    v_permlane16_swap_b32 v25, v29
    v_mfma_f32_16x16x32_bf16 v[96:99], v[48:51], v[224:227], v[96:99]
    ds_read_b128 v[40:43], v6 offset:28672
    ds_read_b128 v[44:47], v6 offset:30720
    v_mfma_f32_16x16x32_bf16 v[96:99], v[52:55], v[232:235], v[96:99]
    buffer_load_dwordx4 a[216:219], v7, s[36:39], s44 offen offset:256 sc1
    v_permlane16_swap_b32 v26, v30
    v_permlane16_swap_b32 v27, v31
    v_mfma_f32_16x16x32_bf16 v[100:103], v[48:51], v[228:231], v[100:103]
    v_add_f32 v24, v24, v28
    v_add_f32 v25, v25, v29
    v_mfma_f32_16x16x32_bf16 v[100:103], v[52:55], v[236:239], v[100:103]
    s_waitcnt lgkmcnt(2)
    v_add_f32 v26, v26, v30
    v_add_f32 v27, v27, v31
    v_mfma_f32_16x16x32_bf16 v[104:107], v[56:59], v[224:227], v[104:107]
    ds_read_b128 v[48:51], v6 offset:28928
    ds_read_b128 v[52:55], v6 offset:30976
    v_mfma_f32_16x16x32_bf16 v[104:107], v[60:63], v[232:235], v[104:107]
    buffer_load_dwordx4 a[220:223], v7, s[36:39], s23 offen offset:256 sc1
    v_mov_b32 v28, v24
    v_mov_b32 v29, v25
    v_mov_b32 v30, v26
    v_mov_b32 v31, v27
    v_mfma_f32_16x16x32_bf16 v[108:111], v[56:59], v[228:231], v[108:111]
    v_permlane32_swap_b32 v24, v28
    v_mfma_f32_16x16x32_bf16 v[108:111], v[60:63], v[236:239], v[108:111]
    s_waitcnt lgkmcnt(2)
    v_permlane32_swap_b32 v25, v29
    v_mfma_f32_16x16x32_bf16 v[68:71], v[40:43], v[244:247], v[68:71]
    ds_read_b128 v[56:59], v6 offset:61440
    ds_read_b128 v[60:63], v6 offset:63488
    v_mfma_f32_16x16x32_bf16 v[68:71], v[44:47], v[252:255], v[68:71]
    buffer_load_dwordx4 a[128:131], v7, s[36:39], s4 offen offset:2048 sc1
    v_permlane32_swap_b32 v26, v30
    v_permlane32_swap_b32 v27, v31
    v_mfma_f32_16x16x32_bf16 v[64:67], v[40:43], v[240:243], v[64:67]
    v_add_f32 v24, v24, v28
    v_add_f32 v25, v25, v29
    v_mfma_f32_16x16x32_bf16 v[64:67], v[44:47], v[248:251], v[64:67]
    s_waitcnt lgkmcnt(2)
    v_add_f32 v26, v26, v30
    v_add_f32 v27, v27, v31
    v_mfma_f32_16x16x32_bf16 v[76:79], v[48:51], v[244:247], v[76:79]
    ds_read_b128 v[40:43], v6 offset:61696
    ds_read_b128 v[44:47], v6 offset:63744
    v_mfma_f32_16x16x32_bf16 v[76:79], v[52:55], v[252:255], v[76:79]
    buffer_load_dwordx4 a[132:135], v7, s[36:39], s20 offen offset:2048 sc1
    v_and_b32 v28, 8, v0
    v_cmp_eq_u32 vcc, 8, v28
    v_and_b32 v28, 16, v0
    v_mov_b32 v30, 0x3727c5ac
    v_mfma_f32_16x16x32_bf16 v[72:75], v[48:51], v[240:243], v[72:75]
    v_cndmask_b32 v24, v24, v25, vcc
    v_cndmask_b32 v26, v26, v27, vcc
    v_mfma_f32_16x16x32_bf16 v[72:75], v[52:55], v[248:251], v[72:75]
    s_waitcnt lgkmcnt(2)
    v_fmamk_f32 v19, v26, 0x3b000000, v30
    v_mfma_f32_16x16x32_bf16 v[84:87], v[56:59], v[244:247], v[84:87]
    ds_read_b128 v[48:51], v8 offset:28672
    ds_read_b128 v[52:55], v8 offset:30720
    v_mfma_f32_16x16x32_bf16 v[84:87], v[60:63], v[252:255], v[84:87]
    buffer_load_dwordx4 a[136:139], v7, s[36:39], s4 offen offset:2304 sc1
    v_rsq_f32 v18, v19
    v_fmamk_f32 v21, v24, 0x3b000000, v30
    v_mfma_f32_16x16x32_bf16 v[80:83], v[56:59], v[240:243], v[80:83]
    v_rsq_f32 v20, v21
    v_mfma_f32_16x16x32_bf16 v[80:83], v[60:63], v[248:251], v[80:83]
    s_waitcnt lgkmcnt(2)
    v_mul_f32 v18, 0xbfb8aa3b, v18
    v_mul_f32 v20, 0xbfb8aa3b, v20
    v_mfma_f32_16x16x32_bf16 v[92:95], v[40:43], v[244:247], v[92:95]
    ds_read_b128 v[56:59], v8 offset:28928
    ds_read_b128 v[60:63], v8 offset:30976
    v_mfma_f32_16x16x32_bf16 v[92:95], v[44:47], v[252:255], v[92:95]
    buffer_load_dwordx4 a[140:143], v7, s[36:39], s20 offen offset:2304 sc1
    v_mfma_f32_16x16x32_bf16 v[88:91], v[40:43], v[240:243], v[88:91]
    v_mfma_f32_16x16x32_bf16 v[88:91], v[44:47], v[248:251], v[88:91]
    s_waitcnt lgkmcnt(2)
    v_mfma_f32_16x16x32_bf16 v[100:103], v[48:51], v[244:247], v[100:103]
    ds_read_b128 v[40:43], v8 offset:32768
    ds_read_b128 v[44:47], v8 offset:34816
    v_mfma_f32_16x16x32_bf16 v[100:103], v[52:55], v[252:255], v[100:103]
    buffer_load_dwordx4 a[144:147], v7, s[36:39], s6 offen offset:2048 sc1
    v_mfma_f32_16x16x32_bf16 v[96:99], v[48:51], v[240:243], v[96:99]
    v_mfma_f32_16x16x32_bf16 v[96:99], v[52:55], v[248:251], v[96:99]
    s_waitcnt lgkmcnt(2)
    v_mfma_f32_16x16x32_bf16 v[108:111], v[56:59], v[244:247], v[108:111]
    ds_read_b128 v[48:51], v8 offset:36864
    ds_read_b128 v[52:55], v8 offset:38912
    v_mfma_f32_16x16x32_bf16 v[108:111], v[60:63], v[252:255], v[108:111]
    buffer_load_dwordx4 a[148:151], v7, s[36:39], s21 offen offset:2048 sc1
    v_mfma_f32_16x16x32_bf16 v[104:107], v[56:59], v[240:243], v[104:107]
    v_mfma_f32_16x16x32_bf16 v[104:107], v[60:63], v[248:251], v[104:107]
    s_waitcnt lgkmcnt(2)
    v_mfma_f32_16x16x32_bf16 v[112:115], v[40:43], v[128:131], 0
    ds_read_b128 v[56:59], v8 offset:40960
    ds_read_b128 v[60:63], v8 offset:43008
    v_mfma_f32_16x16x32_bf16 v[112:115], v[44:47], v[136:139], v[112:115]
    s_barrier
    buffer_load_dwordx4 a[152:155], v7, s[36:39], s6 offen offset:2304 sc1
    v_mfma_f32_16x16x32_bf16 v[116:119], v[40:43], v[132:135], 0
    v_mfma_f32_16x16x32_bf16 v[116:119], v[44:47], v[140:143], v[116:119]
    s_waitcnt lgkmcnt(2)
    v_mfma_f32_16x16x32_bf16 v[116:119], v[48:51], v[148:151], v[116:119]
    ds_read_b128 v[40:43], v8 offset:45056
    ds_read_b128 v[44:47], v8 offset:47104
    v_mfma_f32_16x16x32_bf16 v[116:119], v[52:55], v[156:159], v[116:119]
    s_add_u32 m0, s67, 0
    s_add_u32 s1, s43, 163840
    buffer_load_dwordx4 v16, s[36:39], s1 offen offset:0 sc1 lds
    v_mfma_f32_16x16x32_bf16 v[112:115], v[48:51], v[144:147], v[112:115]
    v_mul_f32 v24, v64, v20
    v_mul_f32 v25, v65, v20
    v_mfma_f32_16x16x32_bf16 v[112:115], v[52:55], v[152:155], v[112:115]
    s_waitcnt lgkmcnt(2)
    v_exp_f32 v24, v24
    v_mfma_f32_16x16x32_bf16 v[112:115], v[56:59], v[160:163], v[112:115]
    ds_read_b128 v[48:51], v8 offset:49152
    ds_read_b128 v[52:55], v8 offset:51200
    v_mfma_f32_16x16x32_bf16 v[112:115], v[60:63], v[168:171], v[112:115]
    buffer_load_dwordx4 v16, s[36:39], s1 offen offset:1024 sc1 lds
    v_exp_f32 v25, v25
    v_mul_f32 v26, v64, v72
    v_mul_f32 v27, v65, v73
    v_mfma_f32_16x16x32_bf16 v[116:119], v[56:59], v[164:167], v[116:119]
    v_fma_f32 v24, v24, v21, v21
    v_fma_f32 v25, v25, v21, v21
    v_mfma_f32_16x16x32_bf16 v[116:119], v[60:63], v[172:175], v[116:119]
    s_waitcnt lgkmcnt(2)
    v_rcp_f32 v24, v24
    v_mfma_f32_16x16x32_bf16 v[116:119], v[40:43], v[180:183], v[116:119]
    ds_read_b128 v[56:59], v8 offset:53248
    ds_read_b128 v[60:63], v8 offset:55296
    v_mfma_f32_16x16x32_bf16 v[116:119], v[44:47], v[188:191], v[116:119]
    buffer_load_dwordx4 v16, s[36:39], s1 offen offset:2048 sc1 lds
    v_rcp_f32 v25, v25
    v_mul_f32 v26, v26, v24
    v_mul_f32 v27, v27, v25
    v_mfma_f32_16x16x32_bf16 v[112:115], v[40:43], v[176:179], v[112:115]
    v_mul_f32 v24, v66, v20
    v_mul_f32 v25, v67, v20
    v_mfma_f32_16x16x32_bf16 v[112:115], v[44:47], v[184:187], v[112:115]
    s_waitcnt lgkmcnt(2)
    v_exp_f32 v24, v24
    v_mfma_f32_16x16x32_bf16 v[112:115], v[48:51], v[192:195], v[112:115]
    ds_read_b128 v[40:43], v8 offset:57344
    ds_read_b128 v[44:47], v8 offset:59392
    v_mfma_f32_16x16x32_bf16 v[112:115], v[52:55], v[200:203], v[112:115]
    buffer_load_dwordx4 v16, s[36:39], s1 offen offset:3072 sc1 lds
    v_exp_f32 v25, v25
    v_mul_f32 v28, v66, v74
    v_mul_f32 v29, v67, v75
    v_mfma_f32_16x16x32_bf16 v[116:119], v[48:51], v[196:199], v[116:119]
    v_fma_f32 v24, v24, v21, v21
    v_fma_f32 v25, v25, v21, v21
    v_mfma_f32_16x16x32_bf16 v[116:119], v[52:55], v[204:207], v[116:119]
    s_waitcnt lgkmcnt(2)
    v_rcp_f32 v24, v24
    v_mfma_f32_16x16x32_bf16 v[116:119], v[56:59], v[212:215], v[116:119]
    ds_read_b128 v[48:51], v8 offset:61440
    ds_read_b128 v[52:55], v8 offset:63488
    v_mfma_f32_16x16x32_bf16 v[116:119], v[60:63], v[220:223], v[116:119]
    s_add_u32 m0, s67, 16384
    s_add_u32 s1, s53, 163840
    buffer_load_dwordx4 v16, s[36:39], s1 offen offset:0 sc1 lds
    v_rcp_f32 v25, v25
    v_mul_f32 v28, v28, v24
    v_mul_f32 v29, v29, v25
    v_mfma_f32_16x16x32_bf16 v[112:115], v[56:59], v[208:211], v[112:115]
    v_cvt_pk_bf16_f32 v32, v26, v27
    v_cvt_pk_bf16_f32 v33, v28, v29
    v_mfma_f32_16x16x32_bf16 v[112:115], v[60:63], v[216:219], v[112:115]
    s_waitcnt lgkmcnt(2)
    v_mul_f32 v24, v68, v18
    v_mul_f32 v25, v69, v18
    v_mfma_f32_16x16x32_bf16 v[112:115], v[40:43], v[224:227], v[112:115]
    ds_read_b128 v[56:59], v8 offset:33024
    ds_read_b128 v[60:63], v8 offset:35072
    v_mfma_f32_16x16x32_bf16 v[112:115], v[44:47], v[232:235], v[112:115]
    buffer_load_dwordx4 v16, s[36:39], s1 offen offset:1024 sc1 lds
    v_exp_f32 v24, v24
    v_exp_f32 v25, v25
    v_mfma_f32_16x16x32_bf16 v[116:119], v[40:43], v[228:231], v[116:119]
    v_mul_f32 v26, v68, v76
    v_mul_f32 v27, v69, v77
    v_mfma_f32_16x16x32_bf16 v[116:119], v[44:47], v[236:239], v[116:119]
    s_waitcnt lgkmcnt(2)
    v_fma_f32 v24, v24, v19, v19
    v_fma_f32 v25, v25, v19, v19
    v_mfma_f32_16x16x32_bf16 v[116:119], v[48:51], v[244:247], v[116:119]
    ds_read_b128 v[40:43], v8 offset:37120
    ds_read_b128 v[44:47], v8 offset:39168
    v_mfma_f32_16x16x32_bf16 v[116:119], v[52:55], v[252:255], v[116:119]
    buffer_load_dwordx4 v16, s[36:39], s1 offen offset:2048 sc1 lds
    v_rcp_f32 v24, v24
    v_rcp_f32 v25, v25
    v_mfma_f32_16x16x32_bf16 v[112:115], v[48:51], v[240:243], v[112:115]
    v_mul_f32 v26, v26, v24
    v_mul_f32 v27, v27, v25
    v_mfma_f32_16x16x32_bf16 v[112:115], v[52:55], v[248:251], v[112:115]
    s_waitcnt lgkmcnt(2)
    v_mul_f32 v24, v70, v18
    v_mul_f32 v25, v71, v18
    v_mfma_f32_16x16x32_bf16 v[120:123], v[56:59], v[128:131], 0
    ds_read_b128 v[48:51], v8 offset:41216
    ds_read_b128 v[52:55], v8 offset:43264
    v_mfma_f32_16x16x32_bf16 v[120:123], v[60:63], v[136:139], v[120:123]
    buffer_load_dwordx4 v16, s[36:39], s1 offen offset:3072 sc1 lds
    v_exp_f32 v24, v24
    v_exp_f32 v25, v25
    v_mfma_f32_16x16x32_bf16 v[124:127], v[56:59], v[132:135], 0
    v_mul_f32 v28, v70, v78
    v_mul_f32 v29, v71, v79
    v_mfma_f32_16x16x32_bf16 v[124:127], v[60:63], v[140:143], v[124:127]
    s_waitcnt lgkmcnt(2)
    v_fma_f32 v24, v24, v19, v19
    v_fma_f32 v25, v25, v19, v19
    v_mfma_f32_16x16x32_bf16 v[124:127], v[40:43], v[148:151], v[124:127]
    ds_read_b128 v[56:59], v8 offset:45312
    ds_read_b128 v[60:63], v8 offset:47360
    v_mfma_f32_16x16x32_bf16 v[124:127], v[44:47], v[156:159], v[124:127]
    s_add_u32 m0, s67, 32768
    s_add_u32 s1, s43, 196608
    buffer_load_dwordx4 v16, s[36:39], s1 offen offset:0 sc1 lds
    v_rcp_f32 v24, v24
    v_rcp_f32 v25, v25
    v_mfma_f32_16x16x32_bf16 v[120:123], v[40:43], v[144:147], v[120:123]
    v_mul_f32 v28, v28, v24
    v_mul_f32 v29, v29, v25
    v_mfma_f32_16x16x32_bf16 v[120:123], v[44:47], v[152:155], v[120:123]
    s_waitcnt lgkmcnt(2)
    v_cvt_pk_bf16_f32 v34, v26, v27
    v_cvt_pk_bf16_f32 v35, v28, v29
    v_mfma_f32_16x16x32_bf16 v[120:123], v[48:51], v[160:163], v[120:123]
    ds_read_b128 v[40:43], v8 offset:49408
    ds_read_b128 v[44:47], v8 offset:51456
    v_mfma_f32_16x16x32_bf16 v[120:123], v[52:55], v[168:171], v[120:123]
    buffer_load_dwordx4 v16, s[36:39], s1 offen offset:1024 sc1 lds
    v_permlane16_swap_b32 v32, v34
    v_permlane16_swap_b32 v33, v35
    v_mfma_f32_16x16x32_bf16 v[124:127], v[48:51], v[164:167], v[124:127]
    v_mul_f32 v24, v80, v20
    v_mul_f32 v25, v81, v20
    v_mfma_f32_16x16x32_bf16 v[124:127], v[52:55], v[172:175], v[124:127]
    s_waitcnt lgkmcnt(2)
    v_exp_f32 v24, v24
    v_mfma_f32_16x16x32_bf16 v[124:127], v[56:59], v[180:183], v[124:127]
    ds_read_b128 v[48:51], v8 offset:53504
    ds_read_b128 v[52:55], v8 offset:55552
    v_mfma_f32_16x16x32_bf16 v[124:127], v[60:63], v[188:191], v[124:127]
    buffer_load_dwordx4 v16, s[36:39], s1 offen offset:2048 sc1 lds
    v_exp_f32 v25, v25
    v_mul_f32 v26, v80, v88
    v_mul_f32 v27, v81, v89
    v_mfma_f32_16x16x32_bf16 v[120:123], v[56:59], v[176:179], v[120:123]
    v_fma_f32 v24, v24, v21, v21
    v_fma_f32 v25, v25, v21, v21
    v_mfma_f32_16x16x32_bf16 v[120:123], v[60:63], v[184:187], v[120:123]
    s_waitcnt lgkmcnt(2)
    v_rcp_f32 v24, v24
    v_mfma_f32_16x16x32_bf16 v[120:123], v[40:43], v[192:195], v[120:123]
    ds_read_b128 v[56:59], v8 offset:57600
    ds_read_b128 v[60:63], v8 offset:59648
    v_mfma_f32_16x16x32_bf16 v[120:123], v[44:47], v[200:203], v[120:123]
    buffer_load_dwordx4 v16, s[36:39], s1 offen offset:3072 sc1 lds
    v_rcp_f32 v25, v25
    v_mul_f32 v26, v26, v24
    v_mul_f32 v27, v27, v25
    v_mfma_f32_16x16x32_bf16 v[124:127], v[40:43], v[196:199], v[124:127]
    s_waitcnt vmcnt(29)
    s_barrier
    v_mfma_f32_16x16x32_bf16 v[124:127], v[44:47], v[204:207], v[124:127]
    s_waitcnt lgkmcnt(2)
    v_mul_f32 v24, v82, v20
    v_mul_f32 v25, v83, v20
    v_mfma_f32_16x16x32_bf16 v[124:127], v[48:51], v[212:215], v[124:127]
    ds_read_b128 v[40:43], v8 offset:61696
    ds_read_b128 v[44:47], v8 offset:63744
    v_mfma_f32_16x16x32_bf16 v[124:127], v[52:55], v[220:223], v[124:127]
    s_add_u32 m0, s67, 49152
    s_add_u32 s1, s53, 196608
    buffer_load_dwordx4 v16, s[36:39], s1 offen offset:0 sc1 lds
    v_exp_f32 v24, v24
    v_exp_f32 v25, v25
    v_mfma_f32_16x16x32_bf16 v[120:123], v[48:51], v[208:211], v[120:123]
    v_mul_f32 v28, v82, v90
    v_mul_f32 v29, v83, v91
    v_mfma_f32_16x16x32_bf16 v[120:123], v[52:55], v[216:219], v[120:123]
    s_waitcnt lgkmcnt(2)
    v_fma_f32 v24, v24, v21, v21
    v_fma_f32 v25, v25, v21, v21
    v_mfma_f32_16x16x32_bf16 v[120:123], v[56:59], v[224:227], v[120:123]
    ds_read_b128 v[48:51], v9 offset:0
    ds_read_b128 v[52:55], v9 offset:2048
    v_mfma_f32_16x16x32_bf16 v[120:123], v[60:63], v[232:235], v[120:123]
    buffer_load_dwordx4 v16, s[36:39], s1 offen offset:1024 sc1 lds
    v_rcp_f32 v24, v24
    v_rcp_f32 v25, v25
    v_mfma_f32_16x16x32_bf16 v[124:127], v[56:59], v[228:231], v[124:127]
    v_mul_f32 v28, v28, v24
    v_mul_f32 v29, v29, v25
    v_mfma_f32_16x16x32_bf16 v[124:127], v[60:63], v[236:239], v[124:127]
    s_waitcnt lgkmcnt(2)
    v_cvt_pk_bf16_f32 v36, v26, v27
    v_cvt_pk_bf16_f32 v37, v28, v29
    v_mfma_f32_16x16x32_bf16 v[124:127], v[40:43], v[244:247], v[124:127]
    ds_read_b128 v[56:59], v9 offset:4096
    ds_read_b128 v[60:63], v9 offset:6144
    v_mfma_f32_16x16x32_bf16 v[124:127], v[44:47], v[252:255], v[124:127]
    buffer_load_dwordx4 v16, s[36:39], s1 offen offset:2048 sc1 lds
    v_mul_f32 v24, v84, v18
    v_mul_f32 v25, v85, v18
    v_exp_f32 v24, v24
    v_mfma_f32_16x16x32_bf16 v[120:123], v[40:43], v[240:243], v[120:123]
    v_exp_f32 v25, v25
    v_mfma_f32_16x16x32_bf16 v[120:123], v[44:47], v[248:251], v[120:123]
    s_waitcnt lgkmcnt(2)
    v_mul_f32 v26, v84, v92
    v_mul_f32 v27, v85, v93
    v_mfma_f32_16x16x32_bf16 v[64:67], v[48:51], v[128:131], 0
    ds_read_b128 v[40:43], v9 offset:8192
    ds_read_b128 v[44:47], v9 offset:10240
    v_mfma_f32_16x16x32_bf16 v[64:67], v[52:55], v[136:139], v[64:67]
    buffer_load_dwordx4 v16, s[36:39], s1 offen offset:3072 sc1 lds
    v_fma_f32 v24, v24, v19, v19
    v_fma_f32 v25, v25, v19, v19
    v_rcp_f32 v24, v24
    v_mfma_f32_16x16x32_bf16 v[68:71], v[48:51], v[132:135], 0
    v_rcp_f32 v25, v25
    v_mfma_f32_16x16x32_bf16 v[68:71], v[52:55], v[140:143], v[68:71]
    s_waitcnt lgkmcnt(2)
    v_mul_f32 v26, v26, v24
    v_mul_f32 v27, v27, v25
    v_mfma_f32_16x16x32_bf16 v[68:71], v[56:59], v[148:151], v[68:71]
    ds_read_b128 v[48:51], v9 offset:12288
    ds_read_b128 v[52:55], v9 offset:14336
    v_mfma_f32_16x16x32_bf16 v[68:71], v[60:63], v[156:159], v[68:71]
    buffer_load_dwordx4 a[156:159], v7, s[36:39], s21 offen offset:2304 sc1
    v_mul_f32 v24, v86, v18
    v_mul_f32 v25, v87, v18
    v_exp_f32 v24, v24
    v_mfma_f32_16x16x32_bf16 v[64:67], v[56:59], v[144:147], v[64:67]
    v_exp_f32 v25, v25
    v_mfma_f32_16x16x32_bf16 v[64:67], v[60:63], v[152:155], v[64:67]
    s_waitcnt lgkmcnt(2)
    v_mul_f32 v28, v86, v94
    v_mul_f32 v29, v87, v95
    v_mfma_f32_16x16x32_bf16 v[64:67], v[40:43], v[160:163], v[64:67]
    ds_read_b128 v[56:59], v9 offset:16384
    ds_read_b128 v[60:63], v9 offset:18432
    v_mfma_f32_16x16x32_bf16 v[64:67], v[44:47], v[168:171], v[64:67]
    buffer_load_dwordx4 a[0:3], v7, s[36:39], s7 offen offset:2048 sc1
    v_fma_f32 v24, v24, v19, v19
    v_fma_f32 v25, v25, v19, v19
    v_rcp_f32 v24, v24
    v_mfma_f32_16x16x32_bf16 v[68:71], v[40:43], v[164:167], v[68:71]
    v_rcp_f32 v25, v25
    v_mfma_f32_16x16x32_bf16 v[68:71], v[44:47], v[172:175], v[68:71]
    s_waitcnt lgkmcnt(2)
    v_mul_f32 v28, v28, v24
    v_mul_f32 v29, v29, v25
    v_cvt_pk_bf16_f32 v38, v26, v27
    v_cvt_pk_bf16_f32 v39, v28, v29
    s_nop 0
    v_permlane16_swap_b32 v36, v38
    v_permlane16_swap_b32 v37, v39
    v_mfma_f32_16x16x32_bf16 v[68:71], v[48:51], v[180:183], v[68:71]
    ds_read_b128 v[40:43], v9 offset:20480
    ds_read_b128 v[44:47], v9 offset:22528
    v_mfma_f32_16x16x32_bf16 v[68:71], v[52:55], v[188:191], v[68:71]
    buffer_store_dwordx4 v[32:35], v16, s[36:39], s28 offen offset:0 sc1
    buffer_store_dwordx4 v[36:39], v16, s[36:39], s28 offen offset:1024 sc1
    v_mul_f32 v24, v96, v20
    v_mul_f32 v25, v97, v20
    v_mfma_f32_16x16x32_bf16 v[64:67], v[48:51], v[176:179], v[64:67]
    v_exp_f32 v24, v24
    v_mfma_f32_16x16x32_bf16 v[64:67], v[52:55], v[184:187], v[64:67]
    s_waitcnt lgkmcnt(2)
    v_exp_f32 v25, v25
    v_mfma_f32_16x16x32_bf16 v[64:67], v[56:59], v[192:195], v[64:67]
    ds_read_b128 v[48:51], v9 offset:24576
    ds_read_b128 v[52:55], v9 offset:26624
    v_mfma_f32_16x16x32_bf16 v[64:67], v[60:63], v[200:203], v[64:67]
    v_mul_f32 v26, v96, v104
    v_mul_f32 v27, v97, v105
    v_fma_f32 v24, v24, v21, v21
    v_fma_f32 v25, v25, v21, v21
    v_mfma_f32_16x16x32_bf16 v[68:71], v[56:59], v[196:199], v[68:71]
    v_rcp_f32 v24, v24
    v_mfma_f32_16x16x32_bf16 v[68:71], v[60:63], v[204:207], v[68:71]
    s_waitcnt lgkmcnt(2)
    v_rcp_f32 v25, v25
    v_mfma_f32_16x16x32_bf16 v[68:71], v[40:43], v[212:215], v[68:71]
    ds_read_b128 v[56:59], v9 offset:28672
    ds_read_b128 v[60:63], v9 offset:30720
    v_mfma_f32_16x16x32_bf16 v[68:71], v[44:47], v[220:223], v[68:71]
    buffer_load_dwordx4 a[4:7], v7, s[36:39], s22 offen offset:2048 sc1
    v_mul_f32 v26, v26, v24
    v_mul_f32 v27, v27, v25
    v_mul_f32 v24, v98, v20
    v_mul_f32 v25, v99, v20
    v_mfma_f32_16x16x32_bf16 v[64:67], v[40:43], v[208:211], v[64:67]
    v_exp_f32 v24, v24
    v_mfma_f32_16x16x32_bf16 v[64:67], v[44:47], v[216:219], v[64:67]
    s_waitcnt lgkmcnt(2)
    v_exp_f32 v25, v25
    v_mfma_f32_16x16x32_bf16 v[64:67], v[48:51], v[224:227], v[64:67]
    ds_read_b128 v[40:43], v9 offset:256
    ds_read_b128 v[44:47], v9 offset:2304
    v_mfma_f32_16x16x32_bf16 v[64:67], v[52:55], v[232:235], v[64:67]
L_pad5:
    s_cbranch_execz L_padret7
    buffer_load_dwordx4 a[8:11], v7, s[36:39], s7 offen offset:2304 sc1
    v_mul_f32 v28, v98, v106
    v_mul_f32 v29, v99, v107
    v_fma_f32 v24, v24, v21, v21
    v_fma_f32 v25, v25, v21, v21
    v_mfma_f32_16x16x32_bf16 v[68:71], v[48:51], v[228:231], v[68:71]
    v_rcp_f32 v24, v24
    v_mfma_f32_16x16x32_bf16 v[68:71], v[52:55], v[236:239], v[68:71]
    s_waitcnt lgkmcnt(2)
    v_rcp_f32 v25, v25
    v_mfma_f32_16x16x32_bf16 v[68:71], v[56:59], v[244:247], v[68:71]
    ds_read_b128 v[48:51], v9 offset:4352
    ds_read_b128 v[52:55], v9 offset:6400
    v_mfma_f32_16x16x32_bf16 v[68:71], v[60:63], v[252:255], v[68:71]
    buffer_load_dwordx4 a[12:15], v7, s[36:39], s22 offen offset:2304 sc1
    v_mul_f32 v28, v28, v24
    v_mul_f32 v29, v29, v25
    v_cvt_pk_bf16_f32 v32, v26, v27
    v_cvt_pk_bf16_f32 v33, v28, v29
    v_mfma_f32_16x16x32_bf16 v[64:67], v[56:59], v[240:243], v[64:67]
    v_mul_f32 v24, v100, v18
    v_mul_f32 v25, v101, v18
    v_mfma_f32_16x16x32_bf16 v[64:67], v[60:63], v[248:251], v[64:67]
    s_waitcnt lgkmcnt(2)
    v_exp_f32 v24, v24
    v_mfma_f32_16x16x32_bf16 v[72:75], v[40:43], v[128:131], 0
    ds_read_b128 v[56:59], v9 offset:8448
    ds_read_b128 v[60:63], v9 offset:10496
    v_mfma_f32_16x16x32_bf16 v[72:75], v[44:47], v[136:139], v[72:75]
    buffer_load_dwordx4 a[16:19], v7, s[36:39], s44 offen offset:2048 sc1
    v_exp_f32 v25, v25
    v_mul_f32 v26, v100, v108
    v_mul_f32 v27, v101, v109
    v_mfma_f32_16x16x32_bf16 v[76:79], v[40:43], v[132:135], 0
    v_fma_f32 v24, v24, v19, v19
    v_fma_f32 v25, v25, v19, v19
    v_mfma_f32_16x16x32_bf16 v[76:79], v[44:47], v[140:143], v[76:79]
    s_waitcnt lgkmcnt(2)
    v_rcp_f32 v24, v24
    v_mfma_f32_16x16x32_bf16 v[76:79], v[48:51], v[148:151], v[76:79]
    ds_read_b128 v[40:43], v9 offset:12544
    ds_read_b128 v[44:47], v9 offset:14592
    v_mfma_f32_16x16x32_bf16 v[76:79], v[52:55], v[156:159], v[76:79]
    buffer_load_dwordx4 a[20:23], v7, s[36:39], s23 offen offset:2048 sc1
    v_rcp_f32 v25, v25
    v_mul_f32 v26, v26, v24
    v_mul_f32 v27, v27, v25
    v_mfma_f32_16x16x32_bf16 v[72:75], v[48:51], v[144:147], v[72:75]
    v_mul_f32 v24, v102, v18
    v_mul_f32 v25, v103, v18
    v_mfma_f32_16x16x32_bf16 v[72:75], v[52:55], v[152:155], v[72:75]
    s_waitcnt lgkmcnt(2)
    v_exp_f32 v24, v24
    v_mfma_f32_16x16x32_bf16 v[72:75], v[56:59], v[160:163], v[72:75]
    ds_read_b128 v[48:51], v9 offset:16640
    ds_read_b128 v[52:55], v9 offset:18688
    v_mfma_f32_16x16x32_bf16 v[72:75], v[60:63], v[168:171], v[72:75]
    buffer_load_dwordx4 a[24:27], v7, s[36:39], s44 offen offset:2304 sc1
    v_exp_f32 v25, v25
    v_mul_f32 v28, v102, v110
    v_mul_f32 v29, v103, v111
    v_mfma_f32_16x16x32_bf16 v[76:79], v[56:59], v[164:167], v[76:79]
    v_fma_f32 v24, v24, v19, v19
    v_fma_f32 v25, v25, v19, v19
    v_mfma_f32_16x16x32_bf16 v[76:79], v[60:63], v[172:175], v[76:79]
    s_waitcnt lgkmcnt(2)
    v_rcp_f32 v24, v24
    v_mfma_f32_16x16x32_bf16 v[76:79], v[40:43], v[180:183], v[76:79]
    ds_read_b128 v[56:59], v9 offset:20736
    ds_read_b128 v[60:63], v9 offset:22784
    v_mfma_f32_16x16x32_bf16 v[76:79], v[44:47], v[188:191], v[76:79]
    buffer_load_dwordx4 a[28:31], v7, s[36:39], s23 offen offset:2304 sc1
    v_rcp_f32 v25, v25
    v_mul_f32 v28, v28, v24
    v_mul_f32 v29, v29, v25
    v_mfma_f32_16x16x32_bf16 v[72:75], v[40:43], v[176:179], v[72:75]
    v_cvt_pk_bf16_f32 v34, v26, v27
    v_cvt_pk_bf16_f32 v35, v28, v29
    v_mfma_f32_16x16x32_bf16 v[72:75], v[44:47], v[184:187], v[72:75]
    s_waitcnt lgkmcnt(2)
    v_permlane16_swap_b32 v32, v34
    v_mfma_f32_16x16x32_bf16 v[72:75], v[48:51], v[192:195], v[72:75]
    ds_read_b128 v[40:43], v9 offset:24832
    ds_read_b128 v[44:47], v9 offset:26880
    v_mfma_f32_16x16x32_bf16 v[72:75], v[52:55], v[200:203], v[72:75]
    buffer_load_dwordx4 a[32:35], v1, s[36:39], s4 offen offset:0 sc1
    v_permlane16_swap_b32 v33, v35
    v_mul_f32 v24, v112, v20
    v_mul_f32 v25, v113, v20
    v_mfma_f32_16x16x32_bf16 v[76:79], v[48:51], v[196:199], v[76:79]
    s_waitcnt vmcnt(12)
    s_barrier
    v_mfma_f32_16x16x32_bf16 v[76:79], v[52:55], v[204:207], v[76:79]
    s_waitcnt lgkmcnt(2)
    v_exp_f32 v24, v24
    v_mfma_f32_16x16x32_bf16 v[76:79], v[56:59], v[212:215], v[76:79]
    ds_read_b128 v[48:51], v9 offset:28928
    ds_read_b128 v[52:55], v9 offset:30976
    v_mfma_f32_16x16x32_bf16 v[76:79], v[60:63], v[220:223], v[76:79]
    buffer_load_dwordx4 a[36:39], v1, s[36:39], s20 offen offset:0 sc1
    v_exp_f32 v25, v25
    v_mul_f32 v26, v112, v120
    v_mul_f32 v27, v113, v121
    v_mfma_f32_16x16x32_bf16 v[72:75], v[56:59], v[208:211], v[72:75]
    v_fma_f32 v24, v24, v21, v21
    v_fma_f32 v25, v25, v21, v21
    v_mfma_f32_16x16x32_bf16 v[72:75], v[60:63], v[216:219], v[72:75]
    s_waitcnt lgkmcnt(2)
    v_rcp_f32 v24, v24
    v_mfma_f32_16x16x32_bf16 v[72:75], v[40:43], v[224:227], v[72:75]
    ds_read_b128 v[56:59], v6 offset:0
    ds_read_b128 v[60:63], v6 offset:2048
    v_mfma_f32_16x16x32_bf16 v[72:75], v[44:47], v[232:235], v[72:75]
    buffer_load_dwordx4 a[40:43], v1, s[36:39], s4 offen offset:256 sc1
    v_rcp_f32 v25, v25
    v_mul_f32 v26, v26, v24
    v_mul_f32 v27, v27, v25
    v_mfma_f32_16x16x32_bf16 v[76:79], v[40:43], v[228:231], v[76:79]
    v_mul_f32 v24, v114, v20
    v_mul_f32 v25, v115, v20
    v_mfma_f32_16x16x32_bf16 v[76:79], v[44:47], v[236:239], v[76:79]
    s_waitcnt lgkmcnt(2)
    v_exp_f32 v24, v24
    v_mfma_f32_16x16x32_bf16 v[76:79], v[48:51], v[244:247], v[76:79]
    ds_read_b128 v[40:43], v6 offset:4096
    ds_read_b128 v[44:47], v6 offset:6144
    v_mfma_f32_16x16x32_bf16 v[76:79], v[52:55], v[252:255], v[76:79]
    buffer_load_dwordx4 a[44:47], v1, s[36:39], s20 offen offset:256 sc1
    v_exp_f32 v25, v25
    v_mul_f32 v28, v114, v122
    v_mul_f32 v29, v115, v123
    v_mfma_f32_16x16x32_bf16 v[72:75], v[48:51], v[240:243], v[72:75]
    v_fma_f32 v24, v24, v21, v21
    v_fma_f32 v25, v25, v21, v21
    v_mfma_f32_16x16x32_bf16 v[72:75], v[52:55], v[248:251], v[72:75]
    s_waitcnt lgkmcnt(2)
    v_rcp_f32 v24, v24
    v_mfma_f32_16x16x32_bf16 v[80:83], v[56:59], v[128:131], 0
    ds_read_b128 v[48:51], v6 offset:8192
    ds_read_b128 v[52:55], v6 offset:10240
    v_mfma_f32_16x16x32_bf16 v[80:83], v[60:63], v[136:139], v[80:83]
    s_waitcnt vmcnt(11)
    s_atomic_add s76, s[36:37], s29 offset:0
    buffer_load_dwordx4 a[48:51], v1, s[36:39], s6 offen offset:0 sc1
    v_rcp_f32 v25, v25
    v_mfma_f32_16x16x32_bf16 v[84:87], v[56:59], v[132:135], 0
    v_mul_f32 v28, v28, v24
    v_mul_f32 v29, v29, v25
    v_mfma_f32_16x16x32_bf16 v[84:87], v[60:63], v[140:143], v[84:87]
    s_waitcnt lgkmcnt(2)
    v_cvt_pk_bf16_f32 v36, v26, v27
    v_cvt_pk_bf16_f32 v37, v28, v29
    v_mfma_f32_16x16x32_bf16 v[84:87], v[40:43], v[148:151], v[84:87]
    ds_read_b128 v[56:59], v6 offset:12288
    ds_read_b128 v[60:63], v6 offset:14336
    v_mfma_f32_16x16x32_bf16 v[84:87], v[44:47], v[156:159], v[84:87]
    buffer_load_dwordx4 a[52:55], v1, s[36:39], s21 offen offset:0 sc1
    v_mul_f32 v24, v116, v18
    v_mul_f32 v25, v117, v18
    v_exp_f32 v24, v24
    v_mfma_f32_16x16x32_bf16 v[80:83], v[40:43], v[144:147], v[80:83]
    v_exp_f32 v25, v25
    v_mfma_f32_16x16x32_bf16 v[80:83], v[44:47], v[152:155], v[80:83]
    s_waitcnt lgkmcnt(2)
    v_mul_f32 v26, v116, v124
    v_mul_f32 v27, v117, v125
    v_mfma_f32_16x16x32_bf16 v[80:83], v[48:51], v[160:163], v[80:83]
    ds_read_b128 v[40:43], v6 offset:16384
    ds_read_b128 v[44:47], v6 offset:18432
    v_mfma_f32_16x16x32_bf16 v[80:83], v[52:55], v[168:171], v[80:83]
    buffer_load_dwordx4 a[56:59], v1, s[36:39], s6 offen offset:256 sc1
    v_fma_f32 v24, v24, v19, v19
    v_fma_f32 v25, v25, v19, v19
    v_rcp_f32 v24, v24
    v_mfma_f32_16x16x32_bf16 v[84:87], v[48:51], v[164:167], v[84:87]
    v_rcp_f32 v25, v25
    v_mfma_f32_16x16x32_bf16 v[84:87], v[52:55], v[172:175], v[84:87]
    s_waitcnt lgkmcnt(2)
    v_mul_f32 v26, v26, v24
    v_mul_f32 v27, v27, v25
    v_mfma_f32_16x16x32_bf16 v[84:87], v[56:59], v[180:183], v[84:87]
    ds_read_b128 v[48:51], v6 offset:20480
    ds_read_b128 v[52:55], v6 offset:22528
    v_mfma_f32_16x16x32_bf16 v[84:87], v[60:63], v[188:191], v[84:87]
    buffer_load_dwordx4 a[60:63], v1, s[36:39], s21 offen offset:256 sc1
    v_mul_f32 v24, v118, v18
    v_mul_f32 v25, v119, v18
    v_exp_f32 v24, v24
    v_mfma_f32_16x16x32_bf16 v[80:83], v[56:59], v[176:179], v[80:83]
    v_exp_f32 v25, v25
    v_mfma_f32_16x16x32_bf16 v[80:83], v[60:63], v[184:187], v[80:83]
    v_mul_f32 v28, v118, v126
    v_mul_f32 v29, v119, v127
    v_fma_f32 v24, v24, v19, v19
    v_fma_f32 v25, v25, v19, v19
    v_rcp_f32 v24, v24
    v_rcp_f32 v25, v25
    v_mul_f32 v28, v28, v24
    v_mul_f32 v29, v29, v25
    v_cvt_pk_bf16_f32 v38, v26, v27
    v_cvt_pk_bf16_f32 v39, v28, v29
    s_nop 0
    v_permlane16_swap_b32 v36, v38
    v_permlane16_swap_b32 v37, v39
    s_waitcnt lgkmcnt(2)
    v_mfma_f32_16x16x32_bf16 v[80:83], v[40:43], v[192:195], v[80:83]
    ds_read_b128 v[56:59], v6 offset:24576
    ds_read_b128 v[60:63], v6 offset:26624
    v_mfma_f32_16x16x32_bf16 v[80:83], v[44:47], v[200:203], v[80:83]
    buffer_store_dwordx4 v[32:35], v16, s[36:39], s28 offen offset:2048 sc1
    buffer_store_dwordx4 v[36:39], v16, s[36:39], s28 offen offset:3072 sc1
    v_mul_f32 v24, v64, v20
    v_mul_f32 v25, v65, v20
    v_mfma_f32_16x16x32_bf16 v[84:87], v[40:43], v[196:199], v[84:87]
    v_exp_f32 v24, v24
    v_mfma_f32_16x16x32_bf16 v[84:87], v[44:47], v[204:207], v[84:87]
    s_waitcnt lgkmcnt(2)
    v_exp_f32 v25, v25
    v_mfma_f32_16x16x32_bf16 v[84:87], v[48:51], v[212:215], v[84:87]
    ds_read_b128 v[40:43], v6 offset:28672
    ds_read_b128 v[44:47], v6 offset:30720
    v_mfma_f32_16x16x32_bf16 v[84:87], v[52:55], v[220:223], v[84:87]
    v_mul_f32 v26, v64, v72
    v_mul_f32 v27, v65, v73
    v_fma_f32 v24, v24, v21, v21
    v_mfma_f32_16x16x32_bf16 v[80:83], v[48:51], v[208:211], v[80:83]
    v_fma_f32 v25, v25, v21, v21
    v_mfma_f32_16x16x32_bf16 v[80:83], v[52:55], v[216:219], v[80:83]
    s_waitcnt lgkmcnt(2)
    v_rcp_f32 v24, v24
    v_mfma_f32_16x16x32_bf16 v[80:83], v[56:59], v[224:227], v[80:83]
    ds_read_b128 v[48:51], v6 offset:256
    ds_read_b128 v[52:55], v6 offset:2304
    v_mfma_f32_16x16x32_bf16 v[80:83], v[60:63], v[232:235], v[80:83]
    s_mov_b32 s57, 0
    s_atomic_add s57, s[36:37], s30 offset:0x0 glc
    buffer_load_dwordx4 a[64:67], v1, s[36:39], s7 offen offset:0 sc1
    v_mfma_f32_16x16x32_bf16 v[84:87], v[56:59], v[228:231], v[84:87]
    v_rcp_f32 v25, v25
    v_mfma_f32_16x16x32_bf16 v[84:87], v[60:63], v[236:239], v[84:87]
    s_waitcnt lgkmcnt(2)
    v_mul_f32 v26, v26, v24
    v_mul_f32 v27, v27, v25
    v_mfma_f32_16x16x32_bf16 v[84:87], v[40:43], v[244:247], v[84:87]
    ds_read_b128 v[56:59], v6 offset:4352
    ds_read_b128 v[60:63], v6 offset:6400
    v_mfma_f32_16x16x32_bf16 v[84:87], v[44:47], v[252:255], v[84:87]
    buffer_load_dwordx4 a[68:71], v1, s[36:39], s22 offen offset:0 sc1
    v_mul_f32 v24, v66, v20
    v_mul_f32 v25, v67, v20
    v_mfma_f32_16x16x32_bf16 v[80:83], v[40:43], v[240:243], v[80:83]
    v_exp_f32 v24, v24
    v_mfma_f32_16x16x32_bf16 v[80:83], v[44:47], v[248:251], v[80:83]
    s_waitcnt lgkmcnt(2)
    v_exp_f32 v25, v25
    v_mfma_f32_16x16x32_bf16 v[88:91], v[48:51], v[128:131], 0
    ds_read_b128 v[40:43], v6 offset:8448
    ds_read_b128 v[44:47], v6 offset:10496
    v_mfma_f32_16x16x32_bf16 v[88:91], v[52:55], v[136:139], v[88:91]
    buffer_load_dwordx4 a[72:75], v1, s[36:39], s7 offen offset:256 sc1
    v_mul_f32 v28, v66, v74
    v_mul_f32 v29, v67, v75
    v_mfma_f32_16x16x32_bf16 v[92:95], v[48:51], v[132:135], 0
    v_fma_f32 v24, v24, v21, v21
    v_fma_f32 v25, v25, v21, v21
    v_mfma_f32_16x16x32_bf16 v[92:95], v[52:55], v[140:143], v[92:95]
    s_waitcnt lgkmcnt(2)
    v_rcp_f32 v24, v24
    v_mfma_f32_16x16x32_bf16 v[92:95], v[56:59], v[148:151], v[92:95]
    ds_read_b128 v[48:51], v6 offset:12544
    ds_read_b128 v[52:55], v6 offset:14592
    v_mfma_f32_16x16x32_bf16 v[92:95], v[60:63], v[156:159], v[92:95]
    buffer_load_dwordx4 a[76:79], v1, s[36:39], s22 offen offset:256 sc1
    v_rcp_f32 v25, v25
    v_mfma_f32_16x16x32_bf16 v[88:91], v[56:59], v[144:147], v[88:91]
    v_mul_f32 v28, v28, v24
    v_mul_f32 v29, v29, v25
    v_mfma_f32_16x16x32_bf16 v[88:91], v[60:63], v[152:155], v[88:91]
    s_waitcnt lgkmcnt(2)
    v_cvt_pk_bf16_f32 v32, v26, v27
    v_cvt_pk_bf16_f32 v33, v28, v29
    v_mfma_f32_16x16x32_bf16 v[88:91], v[40:43], v[160:163], v[88:91]
    ds_read_b128 v[56:59], v6 offset:16640
    ds_read_b128 v[60:63], v6 offset:18688
    v_mfma_f32_16x16x32_bf16 v[88:91], v[44:47], v[168:171], v[88:91]
    buffer_load_dwordx4 a[80:83], v1, s[36:39], s44 offen offset:0 sc1
    v_mul_f32 v24, v68, v18
    v_mul_f32 v25, v69, v18
    v_mfma_f32_16x16x32_bf16 v[92:95], v[40:43], v[164:167], v[92:95]
    v_exp_f32 v24, v24
    v_mfma_f32_16x16x32_bf16 v[92:95], v[44:47], v[172:175], v[92:95]
    s_waitcnt lgkmcnt(2)
    v_exp_f32 v25, v25
    v_mfma_f32_16x16x32_bf16 v[92:95], v[48:51], v[180:183], v[92:95]
    ds_read_b128 v[40:43], v6 offset:20736
    ds_read_b128 v[44:47], v6 offset:22784
    v_mfma_f32_16x16x32_bf16 v[92:95], v[52:55], v[188:191], v[92:95]
    buffer_load_dwordx4 a[84:87], v1, s[36:39], s23 offen offset:0 sc1
    v_mul_f32 v26, v68, v76
    v_mul_f32 v27, v69, v77
    v_mfma_f32_16x16x32_bf16 v[88:91], v[48:51], v[176:179], v[88:91]
    v_fma_f32 v24, v24, v19, v19
    v_fma_f32 v25, v25, v19, v19
    v_mfma_f32_16x16x32_bf16 v[88:91], v[52:55], v[184:187], v[88:91]
    s_waitcnt lgkmcnt(2)
    v_rcp_f32 v24, v24
    v_mfma_f32_16x16x32_bf16 v[88:91], v[56:59], v[192:195], v[88:91]
    ds_read_b128 v[48:51], v6 offset:24832
    ds_read_b128 v[52:55], v6 offset:26880
    v_mfma_f32_16x16x32_bf16 v[88:91], v[60:63], v[200:203], v[88:91]
    buffer_load_dwordx4 a[88:91], v1, s[36:39], s44 offen offset:256 sc1
    v_rcp_f32 v25, v25
    v_mfma_f32_16x16x32_bf16 v[92:95], v[56:59], v[196:199], v[92:95]
    v_mul_f32 v26, v26, v24
    v_mul_f32 v27, v27, v25
    v_mfma_f32_16x16x32_bf16 v[92:95], v[60:63], v[204:207], v[92:95]
    s_waitcnt lgkmcnt(2)
    v_mul_f32 v24, v70, v18
    v_mul_f32 v25, v71, v18
    v_mfma_f32_16x16x32_bf16 v[92:95], v[40:43], v[212:215], v[92:95]
    ds_read_b128 v[56:59], v6 offset:28928
    ds_read_b128 v[60:63], v6 offset:30976
    v_mfma_f32_16x16x32_bf16 v[92:95], v[44:47], v[220:223], v[92:95]
    buffer_load_dwordx4 a[92:95], v1, s[36:39], s23 offen offset:256 sc1
    v_exp_f32 v24, v24
    v_mfma_f32_16x16x32_bf16 v[88:91], v[40:43], v[208:211], v[88:91]
    v_exp_f32 v25, v25
    v_mfma_f32_16x16x32_bf16 v[88:91], v[44:47], v[216:219], v[88:91]
    s_waitcnt lgkmcnt(2)
    v_mul_f32 v28, v70, v78
    v_mul_f32 v29, v71, v79
    v_mfma_f32_16x16x32_bf16 v[88:91], v[48:51], v[224:227], v[88:91]
    ds_read_b128 v[40:43], v6 offset:32768
    ds_read_b128 v[44:47], v6 offset:34816
    v_mfma_f32_16x16x32_bf16 v[88:91], v[52:55], v[232:235], v[88:91]
    buffer_load_dwordx4 a[96:99], v12, s[36:39], s4 offen offset:2048 sc1
    v_fma_f32 v24, v24, v19, v19
    v_fma_f32 v25, v25, v19, v19
    v_mfma_f32_16x16x32_bf16 v[92:95], v[48:51], v[228:231], v[92:95]
    v_rcp_f32 v24, v24
    v_mfma_f32_16x16x32_bf16 v[92:95], v[52:55], v[236:239], v[92:95]
    s_waitcnt lgkmcnt(2)
    v_rcp_f32 v25, v25
    v_mfma_f32_16x16x32_bf16 v[92:95], v[56:59], v[244:247], v[92:95]
    ds_read_b128 v[48:51], v6 offset:33024
    ds_read_b128 v[52:55], v6 offset:35072
    v_mfma_f32_16x16x32_bf16 v[92:95], v[60:63], v[252:255], v[92:95]
    s_waitcnt lgkmcnt(0)
    s_cmp_lt_u32 s57, 8
    s_cbranch_scc1 L_rare13
L_back13:
    buffer_load_dwordx4 a[100:103], v12, s[36:39], s20 offen offset:2048 sc1
    v_mfma_f32_16x16x32_bf16 v[88:91], v[56:59], v[240:243], v[88:91]
    v_mul_f32 v28, v28, v24
    v_mul_f32 v29, v29, v25
    v_mfma_f32_16x16x32_bf16 v[88:91], v[60:63], v[248:251], v[88:91]
    v_cvt_pk_bf16_f32 v34, v26, v27
    v_cvt_pk_bf16_f32 v35, v28, v29
    v_mfma_f32_16x16x32_bf16 v[96:99], v[40:43], v[128:131], 0
    ds_read_b128 v[56:59], v6 offset:36864
    ds_read_b128 v[60:63], v6 offset:38912
    v_mfma_f32_16x16x32_bf16 v[96:99], v[44:47], v[136:139], v[96:99]
    buffer_load_dwordx4 a[104:107], v12, s[36:39], s4 offen offset:2304 sc1
    v_permlane16_swap_b32 v32, v34
    v_mfma_f32_16x16x32_bf16 v[100:103], v[40:43], v[132:135], 0
    v_permlane16_swap_b32 v33, v35
    v_mfma_f32_16x16x32_bf16 v[100:103], v[44:47], v[140:143], v[100:103]
    v_mfma_f32_16x16x32_bf16 v[104:107], v[48:51], v[128:131], 0
    ds_read_b128 v[40:43], v6 offset:37120
    ds_read_b128 v[44:47], v6 offset:39168
    v_mfma_f32_16x16x32_bf16 v[104:107], v[52:55], v[136:139], v[104:107]
    buffer_load_dwordx4 v[128:131], v7, s[36:39], s8 offen offset:0 sc1
    v_mfma_f32_16x16x32_bf16 v[108:111], v[48:51], v[132:135], 0
    v_mul_f32 v24, v80, v20
    v_mul_f32 v25, v81, v20
    v_mfma_f32_16x16x32_bf16 v[108:111], v[52:55], v[140:143], v[108:111]
    s_waitcnt lgkmcnt(2)
    v_exp_f32 v24, v24
    v_mfma_f32_16x16x32_bf16 v[100:103], v[56:59], v[148:151], v[100:103]
    ds_read_b128 v[48:51], v6 offset:40960
    ds_read_b128 v[52:55], v6 offset:43008
    v_mfma_f32_16x16x32_bf16 v[100:103], v[60:63], v[156:159], v[100:103]
    buffer_load_dwordx4 a[108:111], v12, s[36:39], s20 offen offset:2304 sc1
    v_exp_f32 v25, v25
    v_mfma_f32_16x16x32_bf16 v[96:99], v[56:59], v[144:147], v[96:99]
    s_waitcnt vmcnt(13)
    s_atomic_add s76, s[36:37], s29 offset:4
    v_mfma_f32_16x16x32_bf16 v[96:99], v[60:63], v[152:155], v[96:99]
    s_waitcnt lgkmcnt(2)
    v_mul_f32 v26, v80, v88
    v_mul_f32 v27, v81, v89
    v_mfma_f32_16x16x32_bf16 v[108:111], v[40:43], v[148:151], v[108:111]
    ds_read_b128 v[56:59], v6 offset:41216
    ds_read_b128 v[60:63], v6 offset:43264
    v_mfma_f32_16x16x32_bf16 v[108:111], v[44:47], v[156:159], v[108:111]
    buffer_load_dwordx4 a[112:115], v12, s[36:39], s7 offen offset:2048 sc1
    v_fma_f32 v24, v24, v21, v21
    v_fma_f32 v25, v25, v21, v21
    v_mfma_f32_16x16x32_bf16 v[104:107], v[40:43], v[144:147], v[104:107]
    v_rcp_f32 v24, v24
    v_mfma_f32_16x16x32_bf16 v[104:107], v[44:47], v[152:155], v[104:107]
    s_waitcnt lgkmcnt(2)
    buffer_load_dwordx4 v[144:147], v7, s[36:39], s9 offen offset:0 sc1
    v_mfma_f32_16x16x32_bf16 v[96:99], v[48:51], v[160:163], v[96:99]
    ds_read_b128 v[40:43], v6 offset:45056
    ds_read_b128 v[44:47], v6 offset:47104
    v_mfma_f32_16x16x32_bf16 v[96:99], v[52:55], v[168:171], v[96:99]
    v_rcp_f32 v25, v25
    v_mul_f32 v26, v26, v24
    v_mfma_f32_16x16x32_bf16 v[100:103], v[48:51], v[164:167], v[100:103]
    v_mul_f32 v27, v27, v25
    v_mul_f32 v24, v82, v20
    v_mfma_f32_16x16x32_bf16 v[100:103], v[52:55], v[172:175], v[100:103]
    s_waitcnt lgkmcnt(2)
    v_mul_f32 v25, v83, v20
    v_mfma_f32_16x16x32_bf16 v[104:107], v[56:59], v[160:163], v[104:107]
    ds_read_b128 v[48:51], v6 offset:45312
    ds_read_b128 v[52:55], v6 offset:47360
    v_mfma_f32_16x16x32_bf16 v[104:107], v[60:63], v[168:171], v[104:107]
    buffer_load_dwordx4 v[136:139], v7, s[36:39], s8 offen offset:256 sc1
    v_exp_f32 v24, v24
    v_mfma_f32_16x16x32_bf16 v[108:111], v[56:59], v[164:167], v[108:111]
    v_exp_f32 v25, v25
    v_mfma_f32_16x16x32_bf16 v[108:111], v[60:63], v[172:175], v[108:111]
    s_waitcnt lgkmcnt(2)
    buffer_load_dwordx4 v[152:155], v7, s[36:39], s9 offen offset:256 sc1
    v_mul_f32 v28, v82, v90
    v_mfma_f32_16x16x32_bf16 v[100:103], v[40:43], v[180:183], v[100:103]
    ds_read_b128 v[56:59], v6 offset:49152
    ds_read_b128 v[60:63], v6 offset:51200
    v_mfma_f32_16x16x32_bf16 v[100:103], v[44:47], v[188:191], v[100:103]
    v_mul_f32 v29, v83, v91
    v_fma_f32 v24, v24, v21, v21
    v_fma_f32 v25, v25, v21, v21
    v_mfma_f32_16x16x32_bf16 v[96:99], v[40:43], v[176:179], v[96:99]
    v_rcp_f32 v24, v24
    v_mfma_f32_16x16x32_bf16 v[96:99], v[44:47], v[184:187], v[96:99]
    s_waitcnt lgkmcnt(2)
    v_rcp_f32 v25, v25
    v_mfma_f32_16x16x32_bf16 v[108:111], v[48:51], v[180:183], v[108:111]
    ds_read_b128 v[40:43], v6 offset:49408
    ds_read_b128 v[44:47], v6 offset:51456
    v_mfma_f32_16x16x32_bf16 v[108:111], v[52:55], v[188:191], v[108:111]
    buffer_load_dwordx4 v[132:135], v7, s[36:39], s12 offen offset:0 sc1
    v_mul_f32 v28, v28, v24
    v_mul_f32 v29, v29, v25
    v_mfma_f32_16x16x32_bf16 v[104:107], v[48:51], v[176:179], v[104:107]
    v_cvt_pk_bf16_f32 v36, v26, v27
    v_cvt_pk_bf16_f32 v37, v28, v29
    v_mfma_f32_16x16x32_bf16 v[104:107], v[52:55], v[184:187], v[104:107]
    s_waitcnt lgkmcnt(2)
    buffer_load_dwordx4 v[148:151], v7, s[36:39], s13 offen offset:0 sc1
    v_mul_f32 v24, v84, v18
    v_mfma_f32_16x16x32_bf16 v[96:99], v[56:59], v[192:195], v[96:99]
    ds_read_b128 v[48:51], v6 offset:53248
    ds_read_b128 v[52:55], v6 offset:55296
    v_mfma_f32_16x16x32_bf16 v[96:99], v[60:63], v[200:203], v[96:99]
    v_mul_f32 v25, v85, v18
    v_exp_f32 v24, v24
    v_mfma_f32_16x16x32_bf16 v[100:103], v[56:59], v[196:199], v[100:103]
    v_exp_f32 v25, v25
    v_mfma_f32_16x16x32_bf16 v[100:103], v[60:63], v[204:207], v[100:103]
    v_mul_f32 v26, v84, v92
    v_mul_f32 v27, v85, v93
    v_fma_f32 v24, v24, v19, v19
    v_fma_f32 v25, v25, v19, v19
    v_rcp_f32 v24, v24
    v_rcp_f32 v25, v25
    v_mul_f32 v26, v26, v24
    v_mul_f32 v27, v27, v25
    v_mul_f32 v24, v86, v18
    v_mul_f32 v25, v87, v18
    v_exp_f32 v24, v24
    v_exp_f32 v25, v25
    v_mul_f32 v28, v86, v94
    v_mul_f32 v29, v87, v95
    v_fma_f32 v24, v24, v19, v19
    v_fma_f32 v25, v25, v19, v19
    v_rcp_f32 v24, v24
    v_rcp_f32 v25, v25
    v_mul_f32 v28, v28, v24
    v_mul_f32 v29, v29, v25
    v_cvt_pk_bf16_f32 v38, v26, v27
    v_cvt_pk_bf16_f32 v39, v28, v29
    s_nop 0
    v_permlane16_swap_b32 v36, v38
    v_permlane16_swap_b32 v37, v39
    s_waitcnt lgkmcnt(2)
    v_mfma_f32_16x16x32_bf16 v[104:107], v[40:43], v[192:195], v[104:107]
    ds_read_b128 v[56:59], v6 offset:53504
    ds_read_b128 v[60:63], v6 offset:55552
    v_mfma_f32_16x16x32_bf16 v[104:107], v[44:47], v[200:203], v[104:107]
    buffer_store_dwordx4 v[32:35], v11, s[36:39], s28 offen offset:0 sc1
    buffer_store_dwordx4 v[36:39], v11, s[36:39], s28 offen offset:1024 sc1
    buffer_load_dwordx4 v[140:143], v7, s[36:39], s12 offen offset:256 sc1
    v_mfma_f32_16x16x32_bf16 v[108:111], v[40:43], v[196:199], v[108:111]
    v_mfma_f32_16x16x32_bf16 v[108:111], v[44:47], v[204:207], v[108:111]
    s_waitcnt lgkmcnt(2)
    buffer_load_dwordx4 v[156:159], v7, s[36:39], s13 offen offset:256 sc1
    v_mfma_f32_16x16x32_bf16 v[100:103], v[48:51], v[212:215], v[100:103]
    ds_read_b128 v[40:43], v6 offset:57344
    ds_read_b128 v[44:47], v6 offset:59392
    v_mfma_f32_16x16x32_bf16 v[100:103], v[52:55], v[220:223], v[100:103]
    v_mfma_f32_16x16x32_bf16 v[96:99], v[48:51], v[208:211], v[96:99]
    v_mfma_f32_16x16x32_bf16 v[96:99], v[52:55], v[216:219], v[96:99]
    s_waitcnt lgkmcnt(2)
    v_mfma_f32_16x16x32_bf16 v[108:111], v[56:59], v[212:215], v[108:111]
    ds_read_b128 v[48:51], v6 offset:57600
    ds_read_b128 v[52:55], v6 offset:59648
    v_mfma_f32_16x16x32_bf16 v[108:111], v[60:63], v[220:223], v[108:111]
    buffer_load_dwordx4 v[160:163], v7, s[36:39], s10 offen offset:0 sc1
    v_mfma_f32_16x16x32_bf16 v[104:107], v[56:59], v[208:211], v[104:107]
    v_mfma_f32_16x16x32_bf16 v[104:107], v[60:63], v[216:219], v[104:107]
    s_waitcnt lgkmcnt(2)
    buffer_load_dwordx4 v[176:179], v7, s[36:39], s11 offen offset:0 sc1
    v_mfma_f32_16x16x32_bf16 v[96:99], v[40:43], v[224:227], v[96:99]
    ds_read_b128 v[56:59], v6 offset:61440
    ds_read_b128 v[60:63], v6 offset:63488
    v_mfma_f32_16x16x32_bf16 v[96:99], v[44:47], v[232:235], v[96:99]
    v_mfma_f32_16x16x32_bf16 v[100:103], v[40:43], v[228:231], v[100:103]
    v_mfma_f32_16x16x32_bf16 v[100:103], v[44:47], v[236:239], v[100:103]
    s_waitcnt lgkmcnt(2)
    v_mfma_f32_16x16x32_bf16 v[104:107], v[48:51], v[224:227], v[104:107]
    ds_read_b128 v[40:43], v6 offset:61696
    ds_read_b128 v[44:47], v6 offset:63744
    v_mfma_f32_16x16x32_bf16 v[104:107], v[52:55], v[232:235], v[104:107]
    buffer_load_dwordx4 v[168:171], v7, s[36:39], s10 offen offset:256 sc1
    v_mfma_f32_16x16x32_bf16 v[108:111], v[48:51], v[228:231], v[108:111]
    v_mfma_f32_16x16x32_bf16 v[108:111], v[52:55], v[236:239], v[108:111]
    s_waitcnt lgkmcnt(2)
    buffer_load_dwordx4 v[184:187], v7, s[36:39], s11 offen offset:256 sc1
    v_mfma_f32_16x16x32_bf16 v[100:103], v[56:59], v[244:247], v[100:103]
    v_mfma_f32_16x16x32_bf16 v[100:103], v[60:63], v[252:255], v[100:103]
    v_mfma_f32_16x16x32_bf16 v[96:99], v[56:59], v[240:243], v[96:99]
    v_mfma_f32_16x16x32_bf16 v[96:99], v[60:63], v[248:251], v[96:99]
    s_waitcnt lgkmcnt(0)
    v_mfma_f32_16x16x32_bf16 v[108:111], v[40:43], v[244:247], v[108:111]
    v_mfma_f32_16x16x32_bf16 v[108:111], v[44:47], v[252:255], v[108:111]
    buffer_load_dwordx4 v[164:167], v7, s[36:39], s14 offen offset:0 sc1
    v_mfma_f32_16x16x32_bf16 v[104:107], v[40:43], v[240:243], v[104:107]
    v_mfma_f32_16x16x32_bf16 v[104:107], v[44:47], v[248:251], v[104:107]
    buffer_load_dwordx4 v[180:183], v7, s[36:39], s15 offen offset:0 sc1
    s_waitcnt vmcnt(17)
    v_mfma_f32_16x16x32_bf16 v[112:115], a[164:167], v[128:131], 0
    s_mov_b32 s57, 0
    s_atomic_add s57, s[36:37], s30 offset:0x4 glc
    s_waitcnt vmcnt(14)
    v_mfma_f32_16x16x32_bf16 v[112:115], a[180:183], v[144:147], v[112:115]
    v_mfma_f32_16x16x32_bf16 v[120:123], a[172:175], v[128:131], 0
    v_mfma_f32_16x16x32_bf16 v[120:123], a[188:191], v[144:147], v[120:123]
    buffer_load_dwordx4 v[172:175], v7, s[36:39], s14 offen offset:256 sc1
    v_mfma_f32_16x16x32_bf16 v[64:67], a[160:163], v[128:131], 0
    v_mfma_f32_16x16x32_bf16 v[64:67], a[176:179], v[144:147], v[64:67]
    buffer_load_dwordx4 v[188:191], v7, s[36:39], s15 offen offset:256 sc1
    v_mfma_f32_16x16x32_bf16 v[72:75], a[168:171], v[128:131], 0
    v_mul_f32 v24, v96, v20
    v_mul_f32 v25, v97, v20
    v_mfma_f32_16x16x32_bf16 v[72:75], a[184:187], v[144:147], v[72:75]
    v_exp_f32 v24, v24
    s_waitcnt vmcnt(15)
    v_mfma_f32_16x16x32_bf16 v[116:119], a[164:167], v[136:139], 0
    v_exp_f32 v25, v25
    s_waitcnt vmcnt(14)
    v_mfma_f32_16x16x32_bf16 v[116:119], a[180:183], v[152:155], v[116:119]
    buffer_load_dwordx4 a[116:119], v12, s[36:39], s22 offen offset:2048 sc1
    v_mul_f32 v26, v96, v104
    v_mfma_f32_16x16x32_bf16 v[124:127], a[172:175], v[136:139], 0
    v_mul_f32 v27, v97, v105
    v_fma_f32 v24, v24, v21, v21
    v_mfma_f32_16x16x32_bf16 v[124:127], a[188:191], v[152:155], v[124:127]
    v_fma_f32 v25, v25, v21, v21
    v_mfma_f32_16x16x32_bf16 v[68:71], a[160:163], v[136:139], 0
    v_rcp_f32 v24, v24
    v_mfma_f32_16x16x32_bf16 v[68:71], a[176:179], v[152:155], v[68:71]
    buffer_load_dwordx4 a[120:123], v12, s[36:39], s7 offen offset:2304 sc1
    v_mfma_f32_16x16x32_bf16 v[76:79], a[168:171], v[136:139], 0
    v_rcp_f32 v25, v25
    v_mfma_f32_16x16x32_bf16 v[76:79], a[184:187], v[152:155], v[76:79]
    v_mul_f32 v26, v26, v24
    v_mul_f32 v27, v27, v25
    s_waitcnt vmcnt(15)
    v_mfma_f32_16x16x32_bf16 a[240:243], a[164:167], v[132:135], 0
    v_mul_f32 v24, v98, v20
    v_mul_f32 v25, v99, v20
    s_waitcnt vmcnt(14)
    v_mfma_f32_16x16x32_bf16 a[240:243], a[180:183], v[148:151], a[240:243]
    buffer_load_dwordx4 a[124:127], v12, s[36:39], s22 offen offset:2304 sc1
    v_mfma_f32_16x16x32_bf16 a[248:251], a[172:175], v[132:135], 0
    v_exp_f32 v24, v24
    v_mfma_f32_16x16x32_bf16 a[248:251], a[188:191], v[148:151], a[248:251]
    v_exp_f32 v25, v25
    v_mfma_f32_16x16x32_bf16 a[224:227], a[160:163], v[132:135], 0
    v_mul_f32 v28, v98, v106
    v_mul_f32 v29, v99, v107
    v_mfma_f32_16x16x32_bf16 a[224:227], a[176:179], v[148:151], a[224:227]
    v_fma_f32 v24, v24, v21, v21
    v_fma_f32 v25, v25, v21, v21
    v_mfma_f32_16x16x32_bf16 a[232:235], a[168:171], v[132:135], 0
    v_rcp_f32 v24, v24
    v_mfma_f32_16x16x32_bf16 a[232:235], a[184:187], v[148:151], a[232:235]
    v_rcp_f32 v25, v25
    s_waitcnt vmcnt(12)
    v_mfma_f32_16x16x32_bf16 a[244:247], a[164:167], v[140:143], 0
    v_mul_f32 v28, v28, v24
    v_mul_f32 v29, v29, v25
    s_waitcnt vmcnt(11)
    v_mfma_f32_16x16x32_bf16 a[244:247], a[180:183], v[156:159], a[244:247]
    v_cvt_pk_bf16_f32 v32, v26, v27
    v_cvt_pk_bf16_f32 v33, v28, v29
    v_mfma_f32_16x16x32_bf16 a[252:255], a[172:175], v[140:143], 0
    v_mul_f32 v24, v100, v18
    v_mul_f32 v25, v101, v18
    v_mfma_f32_16x16x32_bf16 a[252:255], a[188:191], v[156:159], a[252:255]
    v_exp_f32 v24, v24
    v_mfma_f32_16x16x32_bf16 a[228:231], a[160:163], v[140:143], 0
    v_exp_f32 v25, v25
    v_mfma_f32_16x16x32_bf16 a[228:231], a[176:179], v[156:159], a[228:231]
    v_mul_f32 v26, v100, v108
    v_mul_f32 v27, v101, v109
    v_mfma_f32_16x16x32_bf16 a[236:239], a[168:171], v[140:143], 0
    v_fma_f32 v24, v24, v19, v19
    v_fma_f32 v25, v25, v19, v19
    v_mfma_f32_16x16x32_bf16 a[236:239], a[184:187], v[156:159], a[236:239]
    v_rcp_f32 v24, v24
    s_waitcnt vmcnt(10)
    v_mfma_f32_16x16x32_bf16 v[112:115], a[196:199], v[160:163], v[112:115]
    s_waitcnt lgkmcnt(0)
    s_cmp_lt_u32 s57, 8
    s_cbranch_scc1 L_rare14
L_back14:
    s_waitcnt vmcnt(9)
    v_mfma_f32_16x16x32_bf16 v[112:115], a[212:215], v[176:179], v[112:115]
    buffer_load_dwordx4 v[192:195], v7, s[36:39], s8 offen offset:2048 sc1
    v_mfma_f32_16x16x32_bf16 v[120:123], a[204:207], v[160:163], v[120:123]
L_pad6:
    s_cbranch_execz L_padret7
    s_atomic_add s76, s[36:37], s29 offset:8
    v_mfma_f32_16x16x32_bf16 v[120:123], a[220:223], v[176:179], v[120:123]
    buffer_load_dwordx4 v[208:211], v7, s[36:39], s9 offen offset:2048 sc1
    v_rcp_f32 v25, v25
    v_mul_f32 v26, v26, v24
    v_mul_f32 v27, v27, v25
    v_mul_f32 v24, v102, v18
    v_mul_f32 v25, v103, v18
    v_exp_f32 v24, v24
    v_exp_f32 v25, v25
    v_mul_f32 v28, v102, v110
    v_mul_f32 v29, v103, v111
    v_fma_f32 v24, v24, v19, v19
    v_fma_f32 v25, v25, v19, v19
    v_rcp_f32 v24, v24
    v_rcp_f32 v25, v25
    v_mul_f32 v28, v28, v24
    v_mul_f32 v29, v29, v25
    v_cvt_pk_bf16_f32 v34, v26, v27
    v_cvt_pk_bf16_f32 v35, v28, v29
    s_nop 0
    v_permlane16_swap_b32 v32, v34
    v_permlane16_swap_b32 v33, v35
    v_mfma_f32_16x16x32_bf16 v[64:67], a[192:195], v[160:163], v[64:67]
    v_mfma_f32_16x16x32_bf16 v[64:67], a[208:211], v[176:179], v[64:67]
    buffer_store_dwordx4 v[32:35], v11, s[36:39], s28 offen offset:2048 sc1
    buffer_load_dwordx4 v[200:203], v7, s[36:39], s8 offen offset:2304 sc1
    v_mfma_f32_16x16x32_bf16 v[72:75], a[200:203], v[160:163], v[72:75]
    v_mfma_f32_16x16x32_bf16 v[72:75], a[216:219], v[176:179], v[72:75]
    buffer_load_dwordx4 v[216:219], v7, s[36:39], s9 offen offset:2304 sc1
    s_waitcnt vmcnt(13)
    v_mfma_f32_16x16x32_bf16 v[116:119], a[196:199], v[168:171], v[116:119]
    s_waitcnt vmcnt(12)
    v_mfma_f32_16x16x32_bf16 v[116:119], a[212:215], v[184:187], v[116:119]
    buffer_load_dwordx4 v[196:199], v7, s[36:39], s12 offen offset:2048 sc1
    v_mfma_f32_16x16x32_bf16 v[124:127], a[204:207], v[168:171], v[124:127]
    v_mfma_f32_16x16x32_bf16 v[124:127], a[220:223], v[184:187], v[124:127]
    buffer_load_dwordx4 v[212:215], v7, s[36:39], s13 offen offset:2048 sc1
    v_mfma_f32_16x16x32_bf16 v[68:71], a[192:195], v[168:171], v[68:71]
    v_mfma_f32_16x16x32_bf16 v[68:71], a[208:211], v[184:187], v[68:71]
    buffer_load_dwordx4 v[204:207], v7, s[36:39], s12 offen offset:2304 sc1
    v_mfma_f32_16x16x32_bf16 v[76:79], a[200:203], v[168:171], v[76:79]
    v_mfma_f32_16x16x32_bf16 v[76:79], a[216:219], v[184:187], v[76:79]
    buffer_load_dwordx4 v[220:223], v7, s[36:39], s13 offen offset:2304 sc1
    s_waitcnt vmcnt(15)
    v_mfma_f32_16x16x32_bf16 a[240:243], a[196:199], v[164:167], a[240:243]
    s_waitcnt vmcnt(14)
    v_mfma_f32_16x16x32_bf16 a[240:243], a[212:215], v[180:183], a[240:243]
    buffer_load_dwordx4 v[224:227], v7, s[36:39], s10 offen offset:2048 sc1
    v_mfma_f32_16x16x32_bf16 a[248:251], a[204:207], v[164:167], a[248:251]
    v_mfma_f32_16x16x32_bf16 a[248:251], a[220:223], v[180:183], a[248:251]
    buffer_load_dwordx4 v[240:243], v7, s[36:39], s11 offen offset:2048 sc1
    v_mfma_f32_16x16x32_bf16 a[224:227], a[192:195], v[164:167], a[224:227]
    v_and_b32 v2, 15, v0
    v_lshrrev_b32 v3, 4, v0
    v_mfma_f32_16x16x32_bf16 a[224:227], a[208:211], v[180:183], a[224:227]
    buffer_load_dwordx4 v[232:235], v7, s[36:39], s10 offen offset:2304 sc1
    v_and_b32 v4, 7, v0
    v_mfma_f32_16x16x32_bf16 a[232:235], a[200:203], v[164:167], a[232:235]
    v_xor_b32 v3, v3, v4
    v_lshlrev_b32 v3, 4, v3
    v_mfma_f32_16x16x32_bf16 a[232:235], a[216:219], v[180:183], a[232:235]
    buffer_load_dwordx4 v[248:251], v7, s[36:39], s11 offen offset:2304 sc1
    v_lshl_add_u32 v3, v2, 8, v3
    s_waitcnt vmcnt(17)
    v_mfma_f32_16x16x32_bf16 a[244:247], a[196:199], v[172:175], a[244:247]
    s_mov_b32 s57, 0
    s_atomic_add s57, s[36:37], s30 offset:0x8 glc
    s_waitcnt vmcnt(16)
    v_mfma_f32_16x16x32_bf16 a[244:247], a[212:215], v[188:191], a[244:247]
    s_lshl_b32 s70, s3, 14
    s_lshr_b32 s69, s3, 1
    v_mfma_f32_16x16x32_bf16 a[252:255], a[204:207], v[172:175], a[252:255]
    s_lshl_b32 s69, s69, 13
    s_add_u32 s70, s70, s69
    v_mfma_f32_16x16x32_bf16 a[252:255], a[220:223], v[188:191], a[252:255]
    s_and_b32 s69, s3, 1
    buffer_load_dwordx4 v[228:231], v7, s[36:39], s14 offen offset:2048 sc1
    v_mfma_f32_16x16x32_bf16 a[228:231], a[192:195], v[172:175], a[228:231]
    s_lshl_b32 s69, s69, 7
    s_add_u32 s70, s70, s69
    v_mfma_f32_16x16x32_bf16 a[228:231], a[208:211], v[188:191], a[228:231]
    s_add_u32 s70, s70, 65536
    buffer_load_dwordx4 v[244:247], v7, s[36:39], s15 offen offset:2048 sc1
    v_mfma_f32_16x16x32_bf16 a[236:239], a[200:203], v[172:175], a[236:239]
    v_add_u32 v48, s70, v3
    v_xor_b32 v49, 64, v48
    v_mfma_f32_16x16x32_bf16 a[236:239], a[216:219], v[188:191], a[236:239]
    v_xor_b32 v50, 128, v48
    v_xor_b32 v51, 192, v48
    s_waitcnt vmcnt(14)
    v_mfma_f32_16x16x32_bf16 v[112:115], a[132:135], v[192:195], v[112:115]
    v_xor_b32 v52, 8192, v48
    v_xor_b32 v53, 8256, v48
    s_waitcnt vmcnt(13)
    v_mfma_f32_16x16x32_bf16 v[112:115], a[148:151], v[208:211], v[112:115]
    buffer_load_dwordx4 v[236:239], v7, s[36:39], s14 offen offset:2304 sc1
    v_xor_b32 v54, 8320, v48
    v_mfma_f32_16x16x32_bf16 v[120:123], a[140:143], v[192:195], v[120:123]
    v_xor_b32 v55, 8384, v48
    v_lshrrev_b32 v2, 3, v0
    v_mfma_f32_16x16x32_bf16 v[120:123], a[156:159], v[208:211], v[120:123]
    v_lshlrev_b32 v3, 1, v4
    v_xor_b32 v3, v3, v2
    v_mfma_f32_16x16x32_bf16 v[64:67], a[128:131], v[192:195], v[64:67]
    v_lshlrev_b32 v3, 4, v3
    v_lshl_add_u32 v3, v2, 8, v3
    v_mfma_f32_16x16x32_bf16 v[64:67], a[144:147], v[208:211], v[64:67]
    s_add_u32 s70, s67, 65536
    buffer_load_dwordx4 v[252:255], v7, s[36:39], s15 offen offset:2304 sc1
    v_mfma_f32_16x16x32_bf16 v[72:75], a[136:139], v[192:195], v[72:75]
    v_add_u32 v56, s70, v3
    v_xor_b32 v57, 16, v56
    v_mfma_f32_16x16x32_bf16 v[72:75], a[152:155], v[208:211], v[72:75]
    v_lshlrev_b32 v13, 10, v2
    v_lshl_add_u32 v13, v4, 4, v13
    s_waitcnt vmcnt(13)
    v_mfma_f32_16x16x32_bf16 v[116:119], a[132:135], v[200:203], v[116:119]
    s_add_u32 s69, s41, 8192
    s_waitcnt vmcnt(12)
    v_mfma_f32_16x16x32_bf16 v[116:119], a[148:151], v[216:219], v[116:119]
    v_mfma_f32_16x16x32_bf16 v[124:127], a[140:143], v[200:203], v[124:127]
    v_mfma_f32_16x16x32_bf16 v[124:127], a[156:159], v[216:219], v[124:127]
    v_mfma_f32_16x16x32_bf16 v[68:71], a[128:131], v[200:203], v[68:71]
    v_mfma_f32_16x16x32_bf16 v[68:71], a[144:147], v[216:219], v[68:71]
    v_mfma_f32_16x16x32_bf16 v[76:79], a[136:139], v[200:203], v[76:79]
    v_mfma_f32_16x16x32_bf16 v[76:79], a[152:155], v[216:219], v[76:79]
    s_waitcnt vmcnt(11)
    v_mfma_f32_16x16x32_bf16 a[240:243], a[132:135], v[196:199], a[240:243]
    s_waitcnt vmcnt(10)
    v_mfma_f32_16x16x32_bf16 a[240:243], a[148:151], v[212:215], a[240:243]
    v_mfma_f32_16x16x32_bf16 a[248:251], a[140:143], v[196:199], a[248:251]
    v_mfma_f32_16x16x32_bf16 a[248:251], a[156:159], v[212:215], a[248:251]
    v_mfma_f32_16x16x32_bf16 a[224:227], a[128:131], v[196:199], a[224:227]
    v_mfma_f32_16x16x32_bf16 a[224:227], a[144:147], v[212:215], a[224:227]
    v_mfma_f32_16x16x32_bf16 a[232:235], a[136:139], v[196:199], a[232:235]
    s_waitcnt lgkmcnt(0)
    s_cmp_lt_u32 s57, 8
    s_cbranch_scc1 L_rare15
L_back15:
    v_mfma_f32_16x16x32_bf16 a[232:235], a[152:155], v[212:215], a[232:235]
    buffer_load_dwordx4 v[128:131], v1, s[36:39], s8 offen offset:0 sc1
    s_waitcnt vmcnt(10)
    v_mfma_f32_16x16x32_bf16 a[244:247], a[132:135], v[204:207], a[244:247]
    s_atomic_add s76, s[36:37], s29 offset:12
    s_waitcnt vmcnt(9)
    v_mfma_f32_16x16x32_bf16 a[244:247], a[148:151], v[220:223], a[244:247]
    buffer_load_dwordx4 v[144:147], v1, s[36:39], s9 offen offset:0 sc1
    v_mfma_f32_16x16x32_bf16 a[252:255], a[140:143], v[204:207], a[252:255]
    v_mfma_f32_16x16x32_bf16 a[252:255], a[156:159], v[220:223], a[252:255]
    buffer_load_dwordx4 v[136:139], v1, s[36:39], s8 offen offset:256 sc1
    v_mfma_f32_16x16x32_bf16 a[228:231], a[128:131], v[204:207], a[228:231]
    v_mfma_f32_16x16x32_bf16 a[228:231], a[144:147], v[220:223], a[228:231]
    buffer_load_dwordx4 v[152:155], v1, s[36:39], s9 offen offset:256 sc1
    v_mfma_f32_16x16x32_bf16 a[236:239], a[136:139], v[204:207], a[236:239]
    v_mfma_f32_16x16x32_bf16 a[236:239], a[152:155], v[220:223], a[236:239]
    buffer_load_dwordx4 v[132:135], v1, s[36:39], s12 offen offset:0 sc1
    s_waitcnt vmcnt(12)
    v_mfma_f32_16x16x32_bf16 v[112:115], a[4:7], v[224:227], v[112:115]
    s_waitcnt vmcnt(11)
    v_mfma_f32_16x16x32_bf16 v[112:115], a[20:23], v[240:243], v[112:115]
    buffer_load_dwordx4 v[148:151], v1, s[36:39], s13 offen offset:0 sc1
    v_mfma_f32_16x16x32_bf16 v[120:123], a[12:15], v[224:227], v[120:123]
    v_mfma_f32_16x16x32_bf16 v[120:123], a[28:31], v[240:243], v[120:123]
    v_mfma_f32_16x16x32_bf16 v[64:67], a[0:3], v[224:227], v[64:67]
    v_mfma_f32_16x16x32_bf16 v[64:67], a[16:19], v[240:243], v[64:67]
    buffer_load_dwordx4 v[140:143], v1, s[36:39], s12 offen offset:256 sc1
    v_mfma_f32_16x16x32_bf16 v[72:75], a[8:11], v[224:227], v[72:75]
    v_mfma_f32_16x16x32_bf16 v[72:75], a[24:27], v[240:243], v[72:75]
    buffer_load_dwordx4 v[156:159], v1, s[36:39], s13 offen offset:256 sc1
    s_waitcnt vmcnt(13)
    v_mfma_f32_16x16x32_bf16 v[116:119], a[4:7], v[232:235], v[116:119]
    s_waitcnt vmcnt(12)
    v_mfma_f32_16x16x32_bf16 v[116:119], a[20:23], v[248:251], v[116:119]
    v_mfma_f32_16x16x32_bf16 v[124:127], a[12:15], v[232:235], v[124:127]
    v_mfma_f32_16x16x32_bf16 v[124:127], a[28:31], v[248:251], v[124:127]
    buffer_load_dwordx4 v[40:43], v16, s[36:39], s31 offen sc1
    v_mfma_f32_16x16x32_bf16 v[68:71], a[0:3], v[232:235], v[68:71]
    v_mfma_f32_16x16x32_bf16 v[68:71], a[16:19], v[248:251], v[68:71]
    buffer_load_dwordx4 v[44:47], v16, s[36:39], s31 offen offset:1024 sc1
    v_mfma_f32_16x16x32_bf16 v[76:79], a[8:11], v[232:235], v[76:79]
    v_mfma_f32_16x16x32_bf16 v[76:79], a[24:27], v[248:251], v[76:79]
    buffer_load_dword v15, v14, s[36:39], s40 offen sc1
    s_waitcnt vmcnt(14)
    v_mfma_f32_16x16x32_bf16 a[240:243], a[4:7], v[228:231], a[240:243]
    s_waitcnt vmcnt(13)
    v_mfma_f32_16x16x32_bf16 a[240:243], a[20:23], v[244:247], a[240:243]
    buffer_load_dwordx4 v[160:163], v1, s[36:39], s10 offen offset:0 sc1
    v_mfma_f32_16x16x32_bf16 a[248:251], a[12:15], v[228:231], a[248:251]
    v_mfma_f32_16x16x32_bf16 a[248:251], a[28:31], v[244:247], a[248:251]
    buffer_load_dwordx4 v[176:179], v1, s[36:39], s11 offen offset:0 sc1
    v_mfma_f32_16x16x32_bf16 a[224:227], a[0:3], v[228:231], a[224:227]
    v_mfma_f32_16x16x32_bf16 a[224:227], a[16:19], v[244:247], a[224:227]
    buffer_load_dwordx4 v[168:171], v1, s[36:39], s10 offen offset:256 sc1
    v_mfma_f32_16x16x32_bf16 a[232:235], a[8:11], v[228:231], a[232:235]
    v_mfma_f32_16x16x32_bf16 a[232:235], a[24:27], v[244:247], a[232:235]
    buffer_load_dwordx4 v[184:187], v1, s[36:39], s11 offen offset:256 sc1
    s_waitcnt vmcnt(16)
    v_mfma_f32_16x16x32_bf16 a[244:247], a[4:7], v[236:239], a[244:247]
    s_waitcnt vmcnt(15)
    v_mfma_f32_16x16x32_bf16 a[244:247], a[20:23], v[252:255], a[244:247]
    v_mfma_f32_16x16x32_bf16 a[252:255], a[12:15], v[236:239], a[252:255]
    v_mfma_f32_16x16x32_bf16 a[252:255], a[28:31], v[252:255], a[252:255]
    buffer_load_dwordx4 v[164:167], v1, s[36:39], s14 offen offset:0 sc1
    v_mfma_f32_16x16x32_bf16 a[228:231], a[0:3], v[236:239], a[228:231]
    s_mov_b32 s57, 0
    s_atomic_add s57, s[36:37], s30 offset:0xc glc
    v_mfma_f32_16x16x32_bf16 a[228:231], a[16:19], v[252:255], a[228:231]
    buffer_load_dwordx4 v[180:183], v1, s[36:39], s15 offen offset:0 sc1
    v_mfma_f32_16x16x32_bf16 a[236:239], a[8:11], v[236:239], a[236:239]
    v_mfma_f32_16x16x32_bf16 a[236:239], a[24:27], v[252:255], a[236:239]
    s_waitcnt vmcnt(16)
    v_mfma_f32_16x16x32_bf16 v[112:115], a[36:39], v[128:131], v[112:115]
    s_waitcnt vmcnt(15)
    v_mfma_f32_16x16x32_bf16 v[112:115], a[52:55], v[144:147], v[112:115]
    buffer_load_dwordx4 v[172:175], v1, s[36:39], s14 offen offset:256 sc1
    v_mfma_f32_16x16x32_bf16 v[120:123], a[44:47], v[128:131], v[120:123]
    v_mfma_f32_16x16x32_bf16 v[120:123], a[60:63], v[144:147], v[120:123]
    v_mfma_f32_16x16x32_bf16 v[64:67], a[32:35], v[128:131], v[64:67]
    v_mfma_f32_16x16x32_bf16 v[64:67], a[48:51], v[144:147], v[64:67]
    buffer_load_dwordx4 v[188:191], v1, s[36:39], s15 offen offset:256 sc1
    v_mfma_f32_16x16x32_bf16 v[72:75], a[40:43], v[128:131], v[72:75]
    v_mfma_f32_16x16x32_bf16 v[72:75], a[56:59], v[144:147], v[72:75]
    s_waitcnt vmcnt(16)
    v_mfma_f32_16x16x32_bf16 v[116:119], a[36:39], v[136:139], v[116:119]
    s_waitcnt vmcnt(15)
    v_mfma_f32_16x16x32_bf16 v[116:119], a[52:55], v[152:155], v[116:119]
    v_mfma_f32_16x16x32_bf16 v[124:127], a[44:47], v[136:139], v[124:127]
    v_mfma_f32_16x16x32_bf16 v[124:127], a[60:63], v[152:155], v[124:127]
    v_mfma_f32_16x16x32_bf16 v[68:71], a[32:35], v[136:139], v[68:71]
    v_mfma_f32_16x16x32_bf16 v[68:71], a[48:51], v[152:155], v[68:71]
    v_mfma_f32_16x16x32_bf16 v[76:79], a[40:43], v[136:139], v[76:79]
    v_mfma_f32_16x16x32_bf16 v[76:79], a[56:59], v[152:155], v[76:79]
    s_waitcnt vmcnt(14)
    v_mfma_f32_16x16x32_bf16 a[240:243], a[36:39], v[132:135], a[240:243]
    s_waitcnt vmcnt(13)
    v_mfma_f32_16x16x32_bf16 a[240:243], a[52:55], v[148:151], a[240:243]
    v_mfma_f32_16x16x32_bf16 a[248:251], a[44:47], v[132:135], a[248:251]
    v_mfma_f32_16x16x32_bf16 a[248:251], a[60:63], v[148:151], a[248:251]
    v_mfma_f32_16x16x32_bf16 a[224:227], a[32:35], v[132:135], a[224:227]
    v_mfma_f32_16x16x32_bf16 a[224:227], a[48:51], v[148:151], a[224:227]
    v_mfma_f32_16x16x32_bf16 a[232:235], a[40:43], v[132:135], a[232:235]
    v_mfma_f32_16x16x32_bf16 a[232:235], a[56:59], v[148:151], a[232:235]
    s_waitcnt vmcnt(12)
    v_mfma_f32_16x16x32_bf16 a[244:247], a[36:39], v[140:143], a[244:247]
    s_waitcnt vmcnt(11)
    v_mfma_f32_16x16x32_bf16 a[244:247], a[52:55], v[156:159], a[244:247]
    v_mfma_f32_16x16x32_bf16 a[252:255], a[44:47], v[140:143], a[252:255]
    s_waitcnt lgkmcnt(0)
    s_cmp_lt_u32 s57, 8
    s_cbranch_scc1 L_rare16
L_back16:
    v_mfma_f32_16x16x32_bf16 a[252:255], a[60:63], v[156:159], a[252:255]
    buffer_load_dwordx4 v[192:195], v12, s[36:39], s8 offen offset:2048 sc1
    v_mfma_f32_16x16x32_bf16 a[228:231], a[32:35], v[140:143], a[228:231]
    v_mfma_f32_16x16x32_bf16 a[228:231], a[48:51], v[156:159], a[228:231]
    buffer_load_dwordx4 v[208:211], v12, s[36:39], s10 offen offset:2048 sc1
    v_mfma_f32_16x16x32_bf16 a[236:239], a[40:43], v[140:143], a[236:239]
    v_mfma_f32_16x16x32_bf16 a[236:239], a[56:59], v[156:159], a[236:239]
    buffer_load_dwordx4 v[200:203], v12, s[36:39], s8 offen offset:2304 sc1
    s_waitcnt vmcnt(10)
    v_mfma_f32_16x16x32_bf16 v[112:115], a[68:71], v[160:163], v[112:115]
    s_waitcnt vmcnt(9)
    v_mfma_f32_16x16x32_bf16 v[112:115], a[84:87], v[176:179], v[112:115]
    buffer_load_dwordx4 v[216:219], v12, s[36:39], s10 offen offset:2304 sc1
    v_mfma_f32_16x16x32_bf16 v[120:123], a[76:79], v[160:163], v[120:123]
    v_mfma_f32_16x16x32_bf16 v[120:123], a[92:95], v[176:179], v[120:123]
    buffer_load_dwordx4 v[196:199], v12, s[36:39], s12 offen offset:2048 sc1
    v_mfma_f32_16x16x32_bf16 v[64:67], a[64:67], v[160:163], v[64:67]
    v_mfma_f32_16x16x32_bf16 v[64:67], a[80:83], v[176:179], v[64:67]
    buffer_load_dwordx4 v[212:215], v12, s[36:39], s14 offen offset:2048 sc1
    v_mfma_f32_16x16x32_bf16 v[72:75], a[72:75], v[160:163], v[72:75]
    v_mfma_f32_16x16x32_bf16 v[72:75], a[88:91], v[176:179], v[72:75]
    buffer_load_dwordx4 v[204:207], v12, s[36:39], s12 offen offset:2304 sc1
    s_waitcnt vmcnt(12)
    v_mfma_f32_16x16x32_bf16 v[116:119], a[68:71], v[168:171], v[116:119]
    s_waitcnt vmcnt(11)
    v_mfma_f32_16x16x32_bf16 v[116:119], a[84:87], v[184:187], v[116:119]
    buffer_load_dwordx4 v[220:223], v12, s[36:39], s14 offen offset:2304 sc1
    v_mfma_f32_16x16x32_bf16 v[124:127], a[76:79], v[168:171], v[124:127]
    v_mfma_f32_16x16x32_bf16 v[124:127], a[92:95], v[184:187], v[124:127]
    v_mfma_f32_16x16x32_bf16 v[68:71], a[64:67], v[168:171], v[68:71]
    v_mfma_f32_16x16x32_bf16 v[68:71], a[80:83], v[184:187], v[68:71]
    v_mfma_f32_16x16x32_bf16 v[76:79], a[72:75], v[168:171], v[76:79]
    v_mfma_f32_16x16x32_bf16 v[76:79], a[88:91], v[184:187], v[76:79]
    s_waitcnt vmcnt(11)
    v_mfma_f32_16x16x32_bf16 a[240:243], a[68:71], v[164:167], a[240:243]
    v_mov_b32 v22, v15
    s_waitcnt vmcnt(10)
    v_mfma_f32_16x16x32_bf16 a[240:243], a[84:87], v[180:183], a[240:243]
    v_permlane32_swap_b32 v40, v42
    v_mfma_f32_16x16x32_bf16 a[248:251], a[76:79], v[164:167], a[248:251]
    v_permlane32_swap_b32 v41, v43
    v_mfma_f32_16x16x32_bf16 a[248:251], a[92:95], v[180:183], a[248:251]
    v_permlane32_swap_b32 v44, v46
    v_mfma_f32_16x16x32_bf16 a[224:227], a[64:67], v[164:167], a[224:227]
    v_permlane32_swap_b32 v45, v47
    v_mfma_f32_16x16x32_bf16 a[224:227], a[80:83], v[180:183], a[224:227]
    v_permlane16_swap_b32 v40, v42
    v_mfma_f32_16x16x32_bf16 a[232:235], a[72:75], v[164:167], a[232:235]
    v_permlane16_swap_b32 v41, v43
    v_mfma_f32_16x16x32_bf16 a[232:235], a[88:91], v[180:183], a[232:235]
    v_permlane16_swap_b32 v44, v46
    s_waitcnt vmcnt(9)
    v_mfma_f32_16x16x32_bf16 a[244:247], a[68:71], v[172:175], a[244:247]
    v_permlane16_swap_b32 v45, v47
    s_waitcnt vmcnt(8)
    v_mfma_f32_16x16x32_bf16 a[244:247], a[84:87], v[188:191], a[244:247]
    v_permlane16_swap_b32 v15, v22
    v_mfma_f32_16x16x32_bf16 a[252:255], a[76:79], v[172:175], a[252:255]
    v_lshlrev_b32 v80, 16, v40
    v_and_b32 v81, 0xffff0000, v40
    v_mfma_f32_16x16x32_bf16 a[252:255], a[92:95], v[188:191], a[252:255]
    v_add_f32 v80, v80, v15
    v_add_f32 v81, v81, v15
    v_mfma_f32_16x16x32_bf16 a[228:231], a[64:67], v[172:175], a[228:231]
    v_lshlrev_b32 v82, 16, v41
    v_and_b32 v83, 0xffff0000, v41
    v_mfma_f32_16x16x32_bf16 a[228:231], a[80:83], v[188:191], a[228:231]
    v_add_f32 v82, v82, v15
    v_add_f32 v83, v83, v15
    v_mfma_f32_16x16x32_bf16 a[236:239], a[72:75], v[172:175], a[236:239]
    v_lshlrev_b32 v84, 16, v42
    v_and_b32 v85, 0xffff0000, v42
    v_mfma_f32_16x16x32_bf16 a[236:239], a[88:91], v[188:191], a[236:239]
    v_add_f32 v84, v84, v22
    v_add_f32 v85, v85, v22
    s_waitcnt vmcnt(7)
    v_mfma_f32_16x16x32_bf16 v[112:115], a[100:103], v[192:195], v[112:115]
    v_lshlrev_b32 v86, 16, v43
    v_and_b32 v87, 0xffff0000, v43
    s_waitcnt vmcnt(6)
    v_mfma_f32_16x16x32_bf16 v[112:115], a[116:119], v[208:211], v[112:115]
    v_add_f32 v86, v86, v22
    v_add_f32 v87, v87, v22
    v_mfma_f32_16x16x32_bf16 v[120:123], a[108:111], v[192:195], v[120:123]
    v_lshlrev_b32 v88, 16, v44
    v_and_b32 v89, 0xffff0000, v44
    v_mfma_f32_16x16x32_bf16 v[120:123], a[124:127], v[208:211], v[120:123]
    v_add_f32 v88, v88, v15
    v_add_f32 v89, v89, v15
    s_waitcnt vmcnt(5)
    v_mfma_f32_16x16x32_bf16 v[116:119], a[100:103], v[200:203], v[116:119]
    v_lshlrev_b32 v90, 16, v45
    v_and_b32 v91, 0xffff0000, v45
    s_waitcnt vmcnt(4)
    v_mfma_f32_16x16x32_bf16 v[116:119], a[116:119], v[216:219], v[116:119]
    v_add_f32 v90, v90, v15
    v_add_f32 v91, v91, v15
    v_mfma_f32_16x16x32_bf16 v[124:127], a[108:111], v[200:203], v[124:127]
    v_lshlrev_b32 v92, 16, v46
    v_and_b32 v93, 0xffff0000, v46
    v_mfma_f32_16x16x32_bf16 v[124:127], a[124:127], v[216:219], v[124:127]
    v_add_f32 v92, v92, v22
    v_add_f32 v93, v93, v22
    s_waitcnt vmcnt(3)
    v_mfma_f32_16x16x32_bf16 a[224:227], a[96:99], v[196:199], a[224:227]
    v_lshlrev_b32 v94, 16, v47
    v_and_b32 v95, 0xffff0000, v47
    s_waitcnt vmcnt(2)
    v_mfma_f32_16x16x32_bf16 a[224:227], a[112:115], v[212:215], a[224:227]
    v_add_f32 v94, v94, v22
    v_add_f32 v95, v95, v22
    v_add_f32 v112, v112, v80
    v_add_f32 v113, v113, v81
    v_add_f32 v114, v114, v82
    v_add_f32 v115, v115, v83
    ds_write_b128 v50, v[112:115] offset:0
    v_mfma_f32_16x16x32_bf16 a[232:235], a[104:107], v[196:199], a[232:235]
    v_mfma_f32_16x16x32_bf16 a[232:235], a[120:123], v[212:215], a[232:235]
    v_add_f32 v116, v116, v84
    v_add_f32 v117, v117, v85
    v_add_f32 v118, v118, v86
    v_add_f32 v119, v119, v87
    ds_write_b128 v50, v[116:119] offset:4096
    s_waitcnt vmcnt(1)
    v_mfma_f32_16x16x32_bf16 a[228:231], a[96:99], v[204:207], a[228:231]
    s_waitcnt vmcnt(0)
    v_mfma_f32_16x16x32_bf16 a[228:231], a[112:115], v[220:223], a[228:231]
    v_add_f32 v120, v120, v88
    v_add_f32 v121, v121, v89
    v_add_f32 v122, v122, v90
    v_add_f32 v123, v123, v91
    ds_write_b128 v51, v[120:123] offset:0
    v_mfma_f32_16x16x32_bf16 a[236:239], a[104:107], v[204:207], a[236:239]
    v_mfma_f32_16x16x32_bf16 a[236:239], a[120:123], v[220:223], a[236:239]
    v_add_f32 v124, v124, v92
    v_add_f32 v125, v125, v93
    v_add_f32 v126, v126, v94
    v_add_f32 v127, v127, v95
    ds_write_b128 v51, v[124:127] offset:4096
    v_mfma_f32_16x16x32_bf16 a[240:243], a[100:103], v[196:199], a[240:243]
    v_mfma_f32_16x16x32_bf16 a[240:243], a[116:119], v[212:215], a[240:243]
    ds_write_b128 v52, a[224:227] offset:0
    v_mfma_f32_16x16x32_bf16 a[248:251], a[108:111], v[196:199], a[248:251]
    v_mfma_f32_16x16x32_bf16 a[248:251], a[124:127], v[212:215], a[248:251]
    ds_write_b128 v52, a[228:231] offset:4096
    v_mfma_f32_16x16x32_bf16 a[244:247], a[100:103], v[204:207], a[244:247]
    v_mfma_f32_16x16x32_bf16 a[244:247], a[116:119], v[220:223], a[244:247]
    ds_write_b128 v53, a[232:235] offset:0
    v_mfma_f32_16x16x32_bf16 a[252:255], a[108:111], v[204:207], a[252:255]
    v_mfma_f32_16x16x32_bf16 a[252:255], a[124:127], v[220:223], a[252:255]
    ds_write_b128 v53, a[236:239] offset:4096
    v_mfma_f32_16x16x32_bf16 v[64:67], a[96:99], v[192:195], v[64:67]
    v_mfma_f32_16x16x32_bf16 v[64:67], a[112:115], v[208:211], v[64:67]
    ds_write_b128 v54, a[240:243] offset:0
    v_mfma_f32_16x16x32_bf16 v[72:75], a[104:107], v[192:195], v[72:75]
    v_mfma_f32_16x16x32_bf16 v[72:75], a[120:123], v[208:211], v[72:75]
    ds_write_b128 v54, a[244:247] offset:4096
    v_mfma_f32_16x16x32_bf16 v[68:71], a[96:99], v[200:203], v[68:71]
    v_mfma_f32_16x16x32_bf16 v[68:71], a[112:115], v[216:219], v[68:71]
    ds_write_b128 v55, a[248:251] offset:0
    v_mfma_f32_16x16x32_bf16 v[76:79], a[104:107], v[200:203], v[76:79]
    v_mfma_f32_16x16x32_bf16 v[76:79], a[120:123], v[216:219], v[76:79]
    ds_write_b128 v55, a[252:255] offset:4096
    ds_write_b128 v48, v[64:67] offset:0
    s_nop 2
    ds_write_b128 v48, v[68:71] offset:4096
    ds_write_b128 v49, v[72:75] offset:0
    s_nop 0
    ds_write_b128 v49, v[76:79] offset:4096
    s_waitcnt lgkmcnt(0)
    s_barrier
    ds_read_b128 v[128:131], v56 offset:0
    ds_read_b128 v[132:135], v56 offset:16384
    ds_read_b128 v[136:139], v56 offset:32768
    ds_read_b128 v[140:143], v56 offset:49152
    ds_read_b128 v[144:147], v57 offset:0
    ds_read_b128 v[148:151], v57 offset:16384
    ds_read_b128 v[152:155], v57 offset:32768
    ds_read_b128 v[156:159], v57 offset:49152
    ds_read_b128 v[160:163], v56 offset:2048
    ds_read_b128 v[164:167], v56 offset:18432
    ds_read_b128 v[168:171], v56 offset:34816
    ds_read_b128 v[172:175], v56 offset:51200
    ds_read_b128 v[176:179], v57 offset:2048
    ds_read_b128 v[180:183], v57 offset:18432
    ds_read_b128 v[184:187], v57 offset:34816
    ds_read_b128 v[188:191], v57 offset:51200
    s_waitcnt lgkmcnt(14)
    v_pk_add_f32 v[128:129], v[128:129], v[132:133]
    s_waitcnt lgkmcnt(12)
    v_pk_add_f32 v[136:137], v[136:137], v[140:141]
    v_pk_add_f32 v[128:129], v[128:129], v[136:137]
    v_cvt_pk_bf16_f32 v24, v128, v129
    v_pk_add_f32 v[130:131], v[130:131], v[134:135]
    v_pk_add_f32 v[138:139], v[138:139], v[142:143]
    v_pk_add_f32 v[130:131], v[130:131], v[138:139]
    v_cvt_pk_bf16_f32 v25, v130, v131
    s_waitcnt lgkmcnt(10)
    v_pk_add_f32 v[144:145], v[144:145], v[148:149]
    s_waitcnt lgkmcnt(8)
    v_pk_add_f32 v[152:153], v[152:153], v[156:157]
    v_pk_add_f32 v[144:145], v[144:145], v[152:153]
    v_cvt_pk_bf16_f32 v26, v144, v145
    v_pk_add_f32 v[146:147], v[146:147], v[150:151]
    v_pk_add_f32 v[154:155], v[154:155], v[158:159]
    v_pk_add_f32 v[146:147], v[146:147], v[154:155]
    v_cvt_pk_bf16_f32 v27, v146, v147
    buffer_store_dwordx4 v[24:27], v13, s[32:35], s41 offen sc1
    s_waitcnt lgkmcnt(6)
    v_pk_add_f32 v[160:161], v[160:161], v[164:165]
    s_waitcnt lgkmcnt(4)
    v_pk_add_f32 v[168:169], v[168:169], v[172:173]
    v_pk_add_f32 v[160:161], v[160:161], v[168:169]
    v_cvt_pk_bf16_f32 v28, v160, v161
    v_pk_add_f32 v[162:163], v[162:163], v[166:167]
    v_pk_add_f32 v[170:171], v[170:171], v[174:175]
    v_pk_add_f32 v[162:163], v[162:163], v[170:171]
    v_cvt_pk_bf16_f32 v29, v162, v163
    s_waitcnt lgkmcnt(2)
    v_pk_add_f32 v[176:177], v[176:177], v[180:181]
    s_waitcnt lgkmcnt(0)
    v_pk_add_f32 v[184:185], v[184:185], v[188:189]
    v_pk_add_f32 v[176:177], v[176:177], v[184:185]
    v_cvt_pk_bf16_f32 v30, v176, v177
    v_pk_add_f32 v[178:179], v[178:179], v[182:183]
    v_pk_add_f32 v[186:187], v[186:187], v[190:191]
    v_pk_add_f32 v[178:179], v[178:179], v[186:187]
    v_cvt_pk_bf16_f32 v31, v178, v179
    buffer_store_dwordx4 v[28:31], v13, s[32:35], s69 offen sc1
L_end:
    s_endpgm
L_rare2:
    s_mov_b32 s71, 200000
L_spin1:
    buffer_load_dword v171, v17, s[40:43], 0 offen sc1
    s_waitcnt vmcnt(0)
    v_cmp_gt_u32 vcc, 1, v171
    s_sub_u32 s71, s71, 1
    s_cbranch_scc1 L_fail1
    s_and_b32 vcc_lo, vcc_lo, 0xff
    s_cbranch_scc1 L_spin1
    s_sub_u32 s72, s72, 1
L_fail1:
    s_add_u32 s72, s72, 1
    s_nop 0
    s_branch L_back2
L_rare4:
    ds_read_b128 v[44:47], v253 offset:0
    ds_read_b128 v[48:51], v253 offset:256
    ds_read_b128 v[52:55], v253 offset:512
    ds_read_b128 v[56:59], v253 offset:768
    s_waitcnt lgkmcnt(3)
    v_mfma_f32_16x16x32_bf16 v[124:127], v[44:47], v[20:23], 0
    s_waitcnt lgkmcnt(2)
    v_mfma_f32_16x16x32_bf16 v[124:127], v[48:51], v[20:23], v[124:127]
    s_waitcnt lgkmcnt(1)
    v_mfma_f32_16x16x32_bf16 v[124:127], v[52:55], v[20:23], v[124:127]
    s_waitcnt lgkmcnt(0)
    v_mfma_f32_16x16x32_bf16 v[124:127], v[56:59], v[20:23], v[124:127]
    s_nop 7
    v_add_f32 v124, v124, v125
    v_add_f32 v126, v126, v127
    v_add_f32 v124, v124, v126
    v_mul_f32 v124, 0x3b000000, v124
    v_mov_b32 v125, v124
    s_nop 1
    v_permlane16_swap_b32 v124, v125
    v_cvt_pk_bf16_f32 v124, v124, v125
    v_mov_b32 v125, v124
    s_nop 1
    v_permlane32_swap_b32 v124, v125
    buffer_store_dwordx2 v[124:125], v254, s[36:39], 0 offen sc1
    s_nop 1
    s_branch L_back4
L_rare5:
    s_waitcnt vmcnt(11)
    s_branch L_back5
L_rare8:
    s_mov_b32 s71, 200000
L_spin2:
    buffer_load_dword v23, v251, s[36:39], 0 offen sc1
    s_waitcnt vmcnt(0)
    v_cmp_gt_u32 vcc, 16, v23
    s_sub_u32 s71, s71, 1
    s_cbranch_scc1 L_fail2
    s_and_b32 vcc_lo, vcc_lo, s55
    s_cbranch_scc1 L_spin2
    s_sub_u32 s72, s72, 1
L_fail2:
    s_add_u32 s72, s72, 1
    s_nop 0
    s_branch L_back8
L_rare9:
    s_mov_b32 s71, 200000
L_spin3:
    s_mov_b32 s57, 0
    s_atomic_add s57, s[36:37], s56 offset:0x0 glc
    s_sub_u32 s71, s71, 1
    s_cbranch_scc1 L_fail3
    s_waitcnt lgkmcnt(0)
    s_cmp_lt_u32 s57, 8
    s_cbranch_scc1 L_spin3
    s_sub_u32 s72, s72, 1
L_fail3:
    s_waitcnt lgkmcnt(0)
    s_add_u32 s72, s72, 1
    s_nop 0
    s_branch L_back9
L_rare10:
    s_mov_b32 s71, 200000
L_spin4:
    buffer_load_dword v23, v252, s[36:39], s75 offen sc1
    s_waitcnt vmcnt(0)
    v_cmp_gt_u32 vcc, 16, v23
    s_sub_u32 s71, s71, 1
    s_cbranch_scc1 L_fail4
    s_and_b32 vcc_lo, vcc_lo, 0xffff
    s_cbranch_scc1 L_spin4
    s_sub_u32 s72, s72, 1
L_fail4:
    s_add_u32 s72, s72, 1
    s_nop 0
    s_branch L_back10
L_rare12:
    s_mov_b32 s71, 200000
L_spin5:
    s_mov_b32 s57, 0
    s_atomic_add s57, s[36:37], s42 offset:0x0 glc
    s_sub_u32 s71, s71, 1
    s_cbranch_scc1 L_fail5
    s_waitcnt lgkmcnt(0)
    s_cmp_lt_u32 s57, 16
    s_cbranch_scc1 L_spin5
    s_sub_u32 s72, s72, 1
L_fail5:
    s_waitcnt lgkmcnt(0)
    s_add_u32 s72, s72, 1
    s_nop 0
    s_branch L_back12
L_rare13:
    s_mov_b32 s71, 200000
L_spin6:
    s_mov_b32 s57, 0
    s_atomic_add s57, s[36:37], s30 offset:0x0 glc
    s_sub_u32 s71, s71, 1
    s_cbranch_scc1 L_fail6
    s_waitcnt lgkmcnt(0)
    s_cmp_lt_u32 s57, 8
    s_cbranch_scc1 L_spin6
    s_sub_u32 s72, s72, 1
L_fail6:
    s_waitcnt lgkmcnt(0)
    s_add_u32 s72, s72, 1
    s_nop 0
    s_branch L_back13
L_rare14:
    s_mov_b32 s71, 200000
L_spin7:
    s_mov_b32 s57, 0
    s_atomic_add s57, s[36:37], s30 offset:0x4 glc
    s_sub_u32 s71, s71, 1
    s_cbranch_scc1 L_fail7
    s_waitcnt lgkmcnt(0)
    s_cmp_lt_u32 s57, 8
    s_cbranch_scc1 L_spin7
    s_sub_u32 s72, s72, 1
L_fail7:
    s_waitcnt lgkmcnt(0)
    s_add_u32 s72, s72, 1
    s_nop 0
    s_branch L_back14
L_rare15:
    s_mov_b32 s71, 200000
L_spin8:
    s_mov_b32 s57, 0
    s_atomic_add s57, s[36:37], s30 offset:0x8 glc
    s_sub_u32 s71, s71, 1
    s_cbranch_scc1 L_fail8
    s_waitcnt lgkmcnt(0)
    s_cmp_lt_u32 s57, 8
    s_cbranch_scc1 L_spin8
    s_sub_u32 s72, s72, 1
L_fail8:
    s_waitcnt lgkmcnt(0)
    s_add_u32 s72, s72, 1
    s_nop 0
    s_branch L_back15
L_rare16:
    s_mov_b32 s71, 200000
L_spin9:
    s_mov_b32 s57, 0
    s_atomic_add s57, s[36:37], s30 offset:0xc glc
    s_sub_u32 s71, s71, 1
    s_cbranch_scc1 L_fail9
    s_waitcnt lgkmcnt(0)
    s_cmp_lt_u32 s57, 8
    s_cbranch_scc1 L_spin9
    s_sub_u32 s72, s72, 1
L_fail9:
    s_waitcnt lgkmcnt(0)
    s_add_u32 s72, s72, 1
    s_nop 0
    s_branch L_back16
L_last:
    s_endpgm
.section .rodata,"a"
.p2align 6
.amdhsa_kernel sequential_preLN__linear_attn_block__glu_gated_swiglu__prompt_kernel
  .amdhsa_next_free_vgpr 512
  .amdhsa_next_free_sgpr 102
  .amdhsa_accum_offset 256
  .amdhsa_group_segment_fixed_size 0
  .amdhsa_kernarg_size 80
  .amdhsa_user_sgpr_count 2
  .amdhsa_user_sgpr_kernarg_segment_ptr 1
  .amdhsa_system_sgpr_workgroup_id_x 1
  .amdhsa_float_denorm_mode_32 3
.end_amdhsa_kernel
```
